```python
import torch

def _softmax(x, axis=-1):
    return torch.softmax(x, dim=axis)
def _gelu(x):
    return torch.nn.functional.gelu(x, approximate="tanh")
def _silu(x):
    return torch.nn.functional.silu(x)
def _sigmoid(x):
    return torch.sigmoid(x)
def _layernorm(x, axis=-1, eps=1e-5):
    m = x.mean(dim=axis, keepdim=True)
    v = x.var(dim=axis, keepdim=True, unbiased=False)
    return (x - m) / torch.sqrt(v + eps)
def _scatter_add(tgt, idx, src, axis=0):
    return tgt.clone().index_add_(axis, idx, src)
def _segment_sum(src, seg, n):
    out = torch.zeros((n,) + src.shape[1:], dtype=src.dtype)
    return out.index_add_(0, seg, src)
def _pad(x, pw):
    flat = tuple(v for pair in reversed(pw) for v in pair)
    return torch.nn.functional.pad(x, flat)

kernel_name = 'sequential_preLN__ssm_conv_s4d__moe_arch_mod__prompt'

def setup_inputs():

    _w = (lambda a: (lambda t: t.to(torch.bfloat16) if t.is_floating_point() else t)(torch.as_tensor(a)))
    def _A_setup():
        Bsz, L, D, N = 1, 2048, 512, 128
        return {
            "u": _w((lambda *s: torch.randn(*s, dtype=torch.bfloat16) * 0.05)(Bsz, L, D)),
            "log_A_real": _w((lambda *s: torch.randn(*s, dtype=torch.bfloat16) * 6.4)(D, N) * 0.5),
            "A_imag": _w((lambda *s: torch.randn(*s, dtype=torch.bfloat16) * 0.05)(D, N) * 3.14),
            "C_real": _w((lambda *s: torch.randn(*s, dtype=torch.bfloat16) * 0.05)(D, N) / N ** 0.5),
            "C_imag": _w((lambda *s: torch.randn(*s, dtype=torch.bfloat16) * 0.05)(D, N) / N ** 0.5),
            "log_dt": _w((lambda *s: torch.randn(*s, dtype=torch.bfloat16) * 0.05)(D) * 0.5 - 4.0),
            "D_skip": _w((lambda *s: torch.randn(*s, dtype=torch.bfloat16) * 0.05)(D)),
        }
    _A_in = _A_setup()

    def _B_setup():
        B, S, D, F, C = 1, 2048, 512, 1792, 1
        return {
            "x": _w((lambda *s: torch.randn(*s, dtype=torch.bfloat16) * 0.05)(B, S, D)),
            "w_r": _w((lambda *s: torch.randn(*s, dtype=torch.bfloat16) * 0.05)(D)),
            "w_gate": _w((lambda *s: torch.randn(*s, dtype=torch.bfloat16) * 0.05)(D, F)),
            "w_up": _w((lambda *s: torch.randn(*s, dtype=torch.bfloat16) * 0.05)(D, F)),
            "w_down": _w((lambda *s: torch.randn(*s, dtype=torch.bfloat16) * 0.05)(F, D)),
        }
    _B_in = _B_setup()

    return {
        "A_u": _A_in["u"],
        "A_log_A_real": _A_in["log_A_real"],
        "A_A_imag": _A_in["A_imag"],
        "A_C_real": _A_in["C_real"],
        "A_C_imag": _A_in["C_imag"],
        "A_log_dt": _A_in["log_dt"],
        "A_D_skip": _A_in["D_skip"],
        "B_x": _B_in["x"],
        "B_w_r": _B_in["w_r"],
        "B_w_gate": _B_in["w_gate"],
        "B_w_up": _B_in["w_up"],
        "B_w_down": _B_in["w_down"],
    }

def reference(A_u, A_log_A_real, A_A_imag, A_C_real, A_C_imag, A_log_dt, A_D_skip, B_x, B_w_r, B_w_gate, B_w_up, B_w_down):
    def _A_ref(u, log_A_real, A_imag, C_real, C_imag, log_dt, D_skip):
        L = u.shape[1]
        dt = torch.exp(log_dt)
        A = -torch.exp(log_A_real) + 1j * A_imag
        C = (C_real + 1j * C_imag) * dt[:, None]
        pos = (lambda x, dt: x.to(dt))(torch.arange(L), log_dt.dtype)
        P = torch.exp((A * dt[:, None])[:, :, None] * pos[None, None, :])
        K = 2.0 * torch.einsum("dn,dnl->dl", C, P).real
        L2 = 2 * L
        u_t = (lambda x, *d: x.permute(*d))(u, 0, 2, 1)
        Kf = (lambda x, *a, **k: torch.fft.rfft(x.float(), *a, **k))(K, L2)
        Uf = (lambda x, *a, **k: torch.fft.rfft(x.float(), *a, **k))(u_t, L2)
        y = (lambda x, *a, **k: torch.fft.irfft(x, *a, **k).to(torch.bfloat16))(Uf * Kf[None, :, :], L2)[:, :, :L]
        y = (lambda x, *d: x.permute(*d))(y, 0, 2, 1)
        return y + u * D_skip[None, None, :]

    def _B_ref(x, w_r, w_gate, w_up, w_down):
        B, S, D = x.shape
        C = 1
        r = x @ w_r
        idx = torch.argsort(-r, axis=-1)[:, :C]
        idx_e = (lambda x, n, axis: torch.repeat_interleave(x, n, dim=axis))(idx.reshape(B, C, 1), D, axis=2)
        x_sel = (lambda x, i, axis: torch.take_along_dim(x, i, dim=axis))(x, idx_e, axis=1)
        g = _silu(x_sel @ w_gate)
        u = x_sel @ w_up
        y = (g * u) @ w_down
        r_sel = _sigmoid((lambda x, i, axis: torch.take_along_dim(x, i, dim=axis))(r, idx, axis=1))
        y = y * r_sel.reshape(B, C, 1)
        b_off = (torch.arange(B) * S).reshape(B, 1)
        flat_idx = (idx + b_off).reshape(B * C)
        zero = (x * 0.0).reshape(B * S, D)
        upd = _scatter_add(zero, flat_idx, y.reshape(B * C, D), axis=0)
        return x + upd.reshape(B, S, D)

    x = A_u
    h = x + _A_ref(_layernorm(x, axis=-1), A_log_A_real, A_A_imag, A_C_real, A_C_imag, A_log_dt, A_D_skip)
    h2 = h + _B_ref(_layernorm(h, axis=-1), B_w_r, B_w_gate, B_w_up, B_w_down)
    return h2
```

```asm
; @launch grid=(256,1,1) block=(512,1,1) lds=122432
.amdgcn_target "amdgcn-amd-amdhsa--gfx950"
.text
.globl sequential_preLN__ssm_conv_s4d__moe_arch_mod__prompt_kernel
.p2align 8
.type sequential_preLN__ssm_conv_s4d__moe_arch_mod__prompt_kernel,@function
sequential_preLN__ssm_conv_s4d__moe_arch_mod__prompt_kernel:
    s_cmp_ge_u32 s2, 0x100
    s_cbranch_scc1 L_end
    s_load_dwordx16 s[4:19], s[0:1], 0
    s_load_dwordx8 s[20:27], s[0:1], 64
    s_load_dwordx2 s[28:29], s[0:1], 96
    s_load_dwordx2 s[30:31], s[0:1], 112
    v_lshrrev_b32 v6, 6, v0
    s_lshr_b32 s32, s2, 3
    s_getpc_b64 s[44:45]
L_pc:
    v_lshl_add_u32 v8, s32, 3, v6
    v_and_b32 v8, 63, v8
    v_and_b32 v7, 3, v0
    v_lshl_add_u32 v8, v8, 2, v7
    v_lshlrev_b32 v8, 7, v8
    v_min_u32 v8, L_all_end-L_pc-4, v8
    global_load_dword v4, v8, s[44:45]
    v_readfirstlane_b32 s43, v6
    s_and_b32 s3, s2, 7
    s_lshl_b32 s3, s3, 5
    s_add_u32 s32, s32, s3
    v_and_b32 v0, 0xff, v0
    v_and_b32 v1, 63, v0
    s_and_b32 s33, s43, 3
    s_lshr_b32 s40, s33, 1
    s_and_b32 s41, s33, 1
    s_cmp_ge_u32 s43, 4
    s_cbranch_scc1 L_helper
    s_setprio 2
    v_lshrrev_b32 v7, 5, v0
    v_and_b32 v6, 31, v0
    v_lshlrev_b32 v6, 4, v6
    v_lshl_add_u32 v8, v7, 10, v6
    s_lshl_b32 s42, s32, 13
    v_add_u32 v9, s42, v8
    s_waitcnt lgkmcnt(0)
    global_load_dwordx4 v[10:13], v9, s[4:5]
    global_load_dwordx4 v[14:17], v9, s[4:5] offset:512
    s_load_dword s35, s[30:31], 0
    s_branch L_main
L_helper:
    s_lshr_b32 s3, s32, 6
    s_lshl_b32 s39, s3, 7
    s_and_b32 s3, s32, 31
    s_lshl_b32 s3, s3, 2
    s_add_u32 s39, s39, s3
    s_bfe_u32 s3, s32, 0x10005
    s_add_u32 s39, s39, s3
    s_and_b32 s3, s33, 2
    s_add_u32 s39, s39, s3
    s_lshl_b32 s3, s39, 8
    v_lshl_add_u32 v10, v1, 2, s3
    s_lshl_b32 s3, s39, 1
    s_and_b32 s3, s3, -4
    s_waitcnt lgkmcnt(0)
    global_load_dword v12, v10, s[6:7]
    global_load_dword v13, v10, s[8:9]
    global_load_dword v14, v10, s[10:11]
    global_load_dword v15, v10, s[12:13]
    v_mov_b32 v11, s3
    global_load_dword v11, v11, s[14:15]
    s_branch L_helper2
L_main:
    s_lshl_b32 s3, s33, 11
    s_add_u32 s3, s3, s42
    s_add_u32 s3, s3, 1048576
    v_lshl_add_u32 v26, v1, 4, s3
    s_mov_b32 s3, 34560
    v_lshl_add_u32 v29, v0, 2, s3
    v_mov_b32 v28, 3220750328
    s_mov_b32 s36, 0x3f803f80
    s_mov_b32 s37, 0x3f80
    s_mov_b32 s38, 0x3f800000
    v_and_b32 v2, 15, v0
    v_bfe_u32 v3, v0, 4, 2
    v_mov_b32 v30, -1
    v_mov_b32 v31, -1
    v_mov_b32 v32, -1
    v_mov_b32 v33, -1
    s_lshl_b32 s3, s32, 13
    s_add_u32 s3, s3, 3670016
    s_lshl_b32 s43, s33, 11
    s_add_u32 s3, s3, s43
    v_lshl_add_u32 v27, v1, 4, s3
    v_lshlrev_b32 v6, 3, v3
    v_sub_u32 v6, v6, v2
    v_add_u32 v6, 20, v6
    v_mul_u32_u24 v6, 0x10001, v6
    v_mov_b32 v36, 0x70007
    s_mov_b32 s43, 0xc000c
    s_mov_b32 s3, 2031648
    v_pk_sub_i16 v34, v6, s3
    v_pk_sub_i16 v35, s3, v6
    v_pk_max_i16 v34, v34, v35
    v_pk_min_i16 v34, v34, v36
    v_lshl_or_b32 v54, v34, 8, s43
    s_mov_b32 s3, 1900574
    v_pk_sub_i16 v34, v6, s3
    v_pk_sub_i16 v35, s3, v6
    v_pk_max_i16 v34, v34, v35
    v_pk_min_i16 v34, v34, v36
    v_lshl_or_b32 v55, v34, 8, s43
    s_mov_b32 s3, 1769500
    v_pk_sub_i16 v34, v6, s3
    v_pk_sub_i16 v35, s3, v6
    v_pk_max_i16 v34, v34, v35
    v_pk_min_i16 v34, v34, v36
    v_lshl_or_b32 v56, v34, 8, s43
    s_mov_b32 s3, 1638426
    v_pk_sub_i16 v34, v6, s3
    v_pk_sub_i16 v35, s3, v6
    v_pk_max_i16 v34, v34, v35
    v_pk_min_i16 v34, v34, v36
    v_lshl_or_b32 v57, v34, 8, s43
    s_mov_b32 s3, 1507352
    v_pk_sub_i16 v34, v6, s3
    v_pk_sub_i16 v35, s3, v6
    v_pk_max_i16 v34, v34, v35
    v_pk_min_i16 v34, v34, v36
    v_lshl_or_b32 v58, v34, 8, s43
    s_mov_b32 s3, 1376278
    v_pk_sub_i16 v34, v6, s3
    v_pk_sub_i16 v35, s3, v6
    v_pk_max_i16 v34, v34, v35
    v_pk_min_i16 v34, v34, v36
    v_lshl_or_b32 v59, v34, 8, s43
    s_mov_b32 s3, 15420
    v_perm_b32 v38, 0, s3, v54
    v_perm_b32 v39, 0, s3, v55
    v_perm_b32 v40, 0, s3, v56
    v_perm_b32 v41, 0, s3, v57
    s_mov_b32 s3, 3947580
    v_perm_b32 v42, 0, s3, v56
    v_perm_b32 v43, 0, s3, v57
    v_perm_b32 v44, 0, s3, v58
    v_perm_b32 v45, 0, s3, v59
    s_mov_b32 s3, 1010580540
    v_perm_b32 v46, 0, s3, v56
    v_perm_b32 v47, 0, s3, v57
    v_perm_b32 v48, 0, s3, v58
    v_perm_b32 v49, 0, s3, v59
    s_mov_b32 s3, 1010580540
    v_perm_b32 v50, 60, s3, v56
    v_perm_b32 v51, 60, s3, v57
    v_perm_b32 v52, 60, s3, v58
    v_perm_b32 v53, 60, s3, v59
    s_mul_i32 s3, s40, 4672
    s_add_u32 s43, s3, 16896
    v_lshl_add_u32 v6, v2, 5, s43
    v_lshl_add_u32 v37, v3, 4, v6
    s_mul_i32 s3, s40, 8448
    v_sub_u32 v6, 15, v2
    v_and_b32 v34, 3, v6
    v_and_b32 v6, 12, v6
    v_mul_u32_u24 v34, 2112, v34
    v_lshl_add_u32 v6, v6, 1, v34
    v_add_u32 v6, s3, v6
    v_lshl_add_u32 v62, v3, 4, v6
    v_lshl_add_u32 v63, v3, 3, v6
    v_and_b32 v6, 2, v3
    v_lshl_add_u32 v6, v2, 2, v6
    v_add_u32 v6, s40, v6
    v_lshrrev_b32 v34, 1, v2
    v_xor_b32 v6, v6, v34
    v_and_b32 v34, 1, v3
    v_lshlrev_b32 v34, 3, v34
    v_lshl_add_u32 v60, v6, 4, v34
    v_and_b32 v6, 1, v0
    v_lshrrev_b32 v34, 1, v0
    v_mul_u32_u24 v35, 4672, v6
    v_lshl_add_u32 v61, v34, 4, v35
    v_lshlrev_b32 v6, 4, v6
    v_lshl_add_u32 v35, v34, 13, v6
    s_lshl_b32 s3, s32, 5
    s_add_u32 s3, s3, 1048576
    v_add_u32 v64, s3, v35
    v_add_u32 v65, 0x100000, v64
    v_lshlrev_b32 v54, 2, v7
    s_waitcnt vmcnt(1)
    ds_write_b128 v8, v[10:13] offset:34560
    v_dot2_f32_bf16 v6, v10, s36, 0
    v_dot2_f32_bf16 v34, v10, v10, 0
    v_dot2_f32_bf16 v6, v11, s36, v6
    v_dot2_f32_bf16 v34, v11, v11, v34
    v_dot2_f32_bf16 v6, v12, s36, v6
    v_dot2_f32_bf16 v34, v12, v12, v34
    v_dot2_f32_bf16 v6, v13, s36, v6
    v_dot2_f32_bf16 v34, v13, v13, v34
    s_waitcnt vmcnt(0)
    ds_write_b128 v8, v[14:17] offset:35072
    v_dot2_f32_bf16 v6, v14, s36, v6
    v_dot2_f32_bf16 v34, v14, v14, v34
    v_dot2_f32_bf16 v6, v15, s36, v6
    v_dot2_f32_bf16 v34, v15, v15, v34
    v_dot2_f32_bf16 v6, v16, s36, v6
    v_dot2_f32_bf16 v34, v16, v16, v34
    v_dot2_f32_bf16 v6, v17, s36, v6
    v_dot2_f32_bf16 v34, v17, v17, v34
    s_nop 1
    v_add_f32_dpp v6, v6, v6 quad_perm:[1,0,3,2] row_mask:0xf bank_mask:0xf
    v_add_f32_dpp v34, v34, v34 quad_perm:[1,0,3,2] row_mask:0xf bank_mask:0xf
    s_nop 0
    v_add_f32_dpp v6, v6, v6 quad_perm:[2,3,0,1] row_mask:0xf bank_mask:0xf
    v_add_f32_dpp v34, v34, v34 quad_perm:[2,3,0,1] row_mask:0xf bank_mask:0xf
    s_nop 0
    v_add_f32_dpp v6, v6, v6 row_half_mirror row_mask:0xf bank_mask:0xf
    v_add_f32_dpp v34, v34, v34 row_half_mirror row_mask:0xf bank_mask:0xf
    s_nop 0
    v_add_f32_dpp v6, v6, v6 row_mirror row_mask:0xf bank_mask:0xf
    v_add_f32_dpp v34, v34, v34 row_mirror row_mask:0xf bank_mask:0xf
    v_mov_b32 v55, v6
    v_mov_b32 v56, v34
    s_nop 0
    v_permlane16_swap_b32 v6, v55
    v_permlane16_swap_b32 v34, v56
    v_add_f32 v6, v6, v55
    v_add_f32 v34, v34, v56
    v_mul_f32 v6, 0x3b000000, v6
    v_mul_f32 v34, 0x3b000000, v34
    v_fma_f32 v55, -v6, v6, v34
    v_max_f32 v55, 0, v55
    v_cvt_pk_bf16_f32 v55, 0, v55
    v_cvt_pk_bf16_f32 v35, 0, -v6
    v_add_f32 v55, 0x3727c5ac, v55
    v_cvt_pk_bf16_f32 v55, 0, v55
    v_sqrt_f32 v55, v55
    s_nop 0
    v_cvt_pk_bf16_f32 v55, 0, v55
    v_rcp_f32 v36, v55
    s_mov_b64 exec, 1
    s_bitset1_b64 exec, 32
    v_mul_f32 v36, 0x3d800000, v36
    ds_write_b32 v54, v35 offset:42752
    ds_write_b32 v54, v36 offset:42784
    s_mov_b64 exec, -1
    v_mov_b32 v54, 0
    s_waitcnt lgkmcnt(0)
    s_barrier
    ds_read2st64_b32 v[18:19], v29 offset0:0 offset1:4
    ds_read2st64_b32 v[20:21], v29 offset0:8 offset1:12
    ds_read_b128 v[10:13], v54 offset:42752
    ds_read2st64_b32 v[22:23], v29 offset0:16 offset1:20
    ds_read2st64_b32 v[24:25], v29 offset0:24 offset1:28
    ds_read_b128 v[14:17], v54 offset:42768
    ds_read_b128 v[66:69], v54 offset:42784
    ds_read_b128 v[70:73], v54 offset:42800
    global_store_dwordx4 v27, v[30:33], s[30:31] sc1
    global_store_dwordx4 v27, v[30:33], s[30:31] offset:1024 sc1
    s_add_u32 s35, s35, 1
    s_and_b32 s34, s35, 1074216967
    s_lshr_b32 s46, s35, 3
    s_and_b32 s46, s46, 1074216967
    s_lshr_b32 s47, s35, 6
    s_and_b32 s47, s47, 1074216967
    s_lshr_b32 s48, s35, 9
    s_and_b32 s48, s48, 1074216967
    s_waitcnt lgkmcnt(5)
    v_dot2_f32_bf16 v74, v18, s37, v10
    v_dot2_f32_bf16 v75, v19, s37, v11
    v_dot2_f32_bf16 v76, v20, s37, v12
    v_dot2_f32_bf16 v77, v21, s37, v13
    s_waitcnt lgkmcnt(2)
    v_dot2_f32_bf16 v78, v22, s37, v14
    v_dot2_f32_bf16 v79, v23, s37, v15
    v_dot2_f32_bf16 v80, v24, s37, v16
    v_dot2_f32_bf16 v81, v25, s37, v17
    v_cvt_pk_bf16_f32 v74, 0, v74
    v_cvt_pk_bf16_f32 v75, 0, v75
    v_cvt_pk_bf16_f32 v76, 0, v76
    v_cvt_pk_bf16_f32 v77, 0, v77
    v_cvt_pk_bf16_f32 v78, 0, v78
    v_cvt_pk_bf16_f32 v79, 0, v79
    v_cvt_pk_bf16_f32 v80, 0, v80
    v_cvt_pk_bf16_f32 v81, 0, v81
    s_waitcnt lgkmcnt(1)
    v_pk_mul_f32 v[74:75], v[74:75], v[66:67]
    v_pk_mul_f32 v[76:77], v[76:77], v[68:69]
    s_waitcnt lgkmcnt(0)
    v_pk_mul_f32 v[78:79], v[78:79], v[70:71]
    v_pk_mul_f32 v[80:81], v[80:81], v[72:73]
    v_cvt_pk_bf16_f32 v74, 0, v74
    v_cvt_pk_bf16_f32 v75, 0, v75
    v_cvt_pk_bf16_f32 v76, 0, v76
    v_cvt_pk_bf16_f32 v77, 0, v77
    v_cvt_pk_bf16_f32 v78, 0, v78
    v_cvt_pk_bf16_f32 v79, 0, v79
    v_cvt_pk_bf16_f32 v80, 0, v80
    v_cvt_pk_bf16_f32 v81, 0, v81
    v_cvt_pk_f16_f32 v56, v74, v75
    v_cvt_pk_f16_f32 v57, v76, v77
    v_cvt_pk_f16_f32 v58, v78, v79
    v_cvt_pk_f16_f32 v59, v80, v81
    v_and_or_b32 v56, v56, v28, s34
    v_and_or_b32 v57, v57, v28, s46
    v_and_or_b32 v58, v58, v28, s47
    v_and_or_b32 v59, v59, v28, s48
    v_dot2_f32_bf16 v74, v18, s38, v10
    v_dot2_f32_bf16 v75, v19, s38, v11
    v_dot2_f32_bf16 v76, v20, s38, v12
    v_dot2_f32_bf16 v77, v21, s38, v13
    v_dot2_f32_bf16 v78, v22, s38, v14
    v_dot2_f32_bf16 v79, v23, s38, v15
    v_dot2_f32_bf16 v80, v24, s38, v16
    v_dot2_f32_bf16 v81, v25, s38, v17
    v_cvt_pk_bf16_f32 v74, 0, v74
    v_cvt_pk_bf16_f32 v75, 0, v75
    v_cvt_pk_bf16_f32 v76, 0, v76
    v_cvt_pk_bf16_f32 v77, 0, v77
    v_cvt_pk_bf16_f32 v78, 0, v78
    v_cvt_pk_bf16_f32 v79, 0, v79
    v_cvt_pk_bf16_f32 v80, 0, v80
    v_cvt_pk_bf16_f32 v81, 0, v81
    v_pk_mul_f32 v[74:75], v[74:75], v[66:67]
    v_pk_mul_f32 v[76:77], v[76:77], v[68:69]
    v_pk_mul_f32 v[78:79], v[78:79], v[70:71]
    v_pk_mul_f32 v[80:81], v[80:81], v[72:73]
    v_cvt_pk_bf16_f32 v74, 0, v74
    v_cvt_pk_bf16_f32 v75, 0, v75
    v_cvt_pk_bf16_f32 v76, 0, v76
    v_cvt_pk_bf16_f32 v77, 0, v77
    v_cvt_pk_bf16_f32 v78, 0, v78
    v_cvt_pk_bf16_f32 v79, 0, v79
    v_cvt_pk_bf16_f32 v80, 0, v80
    v_cvt_pk_bf16_f32 v81, 0, v81
    v_cvt_pk_f16_f32 v82, v74, v75
    v_cvt_pk_f16_f32 v83, v76, v77
    v_cvt_pk_f16_f32 v84, v78, v79
    v_cvt_pk_f16_f32 v85, v80, v81
    v_and_or_b32 v82, v82, v28, s34
    v_and_or_b32 v83, v83, v28, s46
    v_and_or_b32 v84, v84, v28, s47
    v_and_or_b32 v85, v85, v28, s48
    s_waitcnt vmcnt(0)
    global_store_dwordx4 v26, v[56:59], s[30:31] offset:0 sc1
    global_store_dwordx4 v26, v[82:85], s[30:31] offset:1024 sc1
    s_setprio 0
    v_mov_b32 v10, 152
    s_mul_i32 s3, s32, 2432
    s_add_u32 s3, s3, 32768
    v_lshl_add_u32 v11, v0, 4, s3
    v_cmp_gt_u32 s[10:11], v10, v0
    v_mov_b32 v17, v11
    s_lshr_b32 s3, s32, 5
    s_and_b32 s43, s32, 31
    s_mul_i32 s6, s43, 57344
    s_mul_i32 s7, s3, 448
    s_add_u32 s6, s6, s7
    v_lshrrev_b32 v6, 2, v1
    v_and_b32 v10, 3, v0
    v_mul_u32_u24 v6, 3584, v6
    v_lshl_add_u32 v6, v10, 7, v6
    v_add_u32 v6, s6, v6
    s_mul_i32 s6, s43, 57344
    s_lshl_b32 s7, s3, 7
    s_add_u32 s6, s6, s7
    s_mul_i32 s7, s41, 28672
    s_add_u32 s6, s6, s7
    v_min_u32 v10, 27, v1
    v_lshl_add_u32 v10, v10, 10, s6
    s_cmp_eq_u32 s33, 0
    s_cselect_b32 s8, s22, s24
    s_cselect_b32 s9, s23, s25
    s_cmp_lt_u32 s33, 2
    s_cselect_b32 s8, s8, s26
    s_cselect_b32 s9, s9, s27
    s_cselect_b64 vcc, -1, 0
    v_cndmask_b32 v6, v10, v6, vcc
    v_mov_b32 v18, v6
    s_lshr_b32 s3, s32, 5
    s_and_b32 s43, s32, 31
    s_cmp_ge_u32 s43, 7
    s_cselect_b32 s51, 1, 0
    s_cselect_b32 s6, 7, 0
    s_sub_u32 s6, s43, s6
    s_mul_i32 s49, s3, 7
    s_add_u32 s49, s49, s6
    s_cmp_ge_u32 s43, 14
    s_cselect_b32 s50, 2, 0
    s_lshl_b32 s3, s3, 2
    s_sub_u32 s6, s43, 28
    s_add_u32 s3, s3, s6
    s_cmp_lt_u32 s6, 4
    s_cselect_b32 s50, 1, s50
    s_cselect_b32 s49, s3, s49
    s_lshl_b32 s3, s32, 13
    s_add_u32 s3, s3, 3670016
    v_lshl_add_u32 v12, v0, 4, s3
    v_add_u32 v13, 0x1000, v12
    v_bfe_u32 v6, v0, 3, 3
    v_xor_b32 v6, v0, v6
    v_lshlrev_b32 v16, 4, v6
    s_lshl_b32 s3, s33, 13
    s_add_u32 s3, s3, s32
    s_sub_u32 s3, s3, s32
    s_lshl_b32 s3, s3, 5
    s_add_u32 s3, s3, 2621440
    v_add_u32 v14, s3, v64
    v_add_u32 v15, 0x40000, v14
    s_mov_b64 exec, s[10:11]
    global_store_dwordx4 v17, v[30:33], s[30:31] sc1
    s_mov_b64 exec, -1
    v_and_b32 v6, 0x1ff, v8
    v_lshlrev_b32 v10, 2, v0
    global_load_dwordx4 v[20:23], v6, s[20:21]
    global_load_dwordx4 v[24:27], v6, s[20:21] offset:512
    global_load_dword v11, v10, s[16:17]
    s_lshl_b32 s3, s40, 2
    v_mov_b32 v6, s3
    s_barrier
    global_load_dwordx4 v[66:69], v64, s[30:31] sc1
    global_load_dwordx4 v[70:73], v65, s[30:31] sc1
    s_branch L_pad_rec
.p2alignl 12, 0xbf810000
L_pad_rec:
    s_barrier
    ds_read_b32 v6, v6 offset:42864
    s_waitcnt vmcnt(1)
    v_xor_b32 v66, s34, v66
    v_xor_b32 v67, s46, v67
    v_xor_b32 v68, s47, v68
    v_xor_b32 v69, s48, v69
    s_waitcnt vmcnt(0)
    v_xor_b32 v70, s34, v70
    v_xor_b32 v71, s46, v71
    v_xor_b32 v72, s47, v72
    v_xor_b32 v73, s48, v73
    v_or3_b32 v10, v66, v67, v68
    v_or3_b32 v17, v69, v70, v71
    v_or3_b32 v10, v10, v72, v73
    v_or_b32 v10, v10, v17
    v_and_b32 v10, 1074216967, v10
    v_cmp_ne_u32 vcc, 0, v10
    s_cbranch_vccnz L_s1_slow
L_s1_ok:
    ds_write_b128 v61, v[66:69] offset:17408
    ds_write_b128 v61, v[70:73] offset:19456
    s_cmp_eq_u32 s41, 0
    s_cbranch_scc0 L_conv_b
    s_waitcnt lgkmcnt(0)
    s_barrier
    ds_read_b64 a[0:1], v62 offset:576
    ds_read_b64 a[2:3], v62 offset:584
    ds_read_b128 a[4:7], v37 offset:32
    ds_read_b64 a[8:9], v62 offset:64
    ds_read_b64 a[10:11], v62 offset:72
    ds_read_b64 a[12:13], v62 offset:640
    ds_read_b64 a[14:15], v62 offset:648
    ds_read_b128 a[16:19], v37 offset:96
    ds_read_b128 a[20:23], v37 offset:480
    s_waitcnt lgkmcnt(6)
    v_mfma_f32_16x16x32_f16 v[64:67], a[0:3], a[4:7], 0
    s_waitcnt lgkmcnt(4)
    ds_read_b64 a[24:25], v62 offset:128
    ds_read_b64 a[26:27], v62 offset:136
    ds_read_b64 a[28:29], v62 offset:704
    ds_read_b64 a[30:31], v62 offset:712
    ds_read_b128 a[32:35], v37 offset:160
    v_mfma_f32_16x16x32_f16 v[68:71], a[8:11], a[4:7], 0
    s_waitcnt lgkmcnt(6)
    ds_read_b64 a[36:37], v62 offset:192
    ds_read_b64 a[38:39], v62 offset:200
    v_mfma_f32_16x16x32_f16 v[64:67], a[12:15], a[16:19], v[64:67]
    s_waitcnt lgkmcnt(7)
    ds_read_b64 a[40:41], v62 offset:768
    ds_read_b64 a[42:43], v62 offset:776
    v_mfma_f32_16x16x32_f16 v[72:75], a[20:23], v[38:41], 0
    s_waitcnt lgkmcnt(7)
    ds_read_b128 a[44:47], v37 offset:224
    ds_read_b128 a[48:51], v37 offset:464
    v_mfma_f32_16x16x32_f16 v[68:71], a[24:27], a[16:19], v[68:71]
    s_waitcnt lgkmcnt(6)
    ds_read_b64 a[52:53], v62 offset:256
    ds_read_b64 a[54:55], v62 offset:264
    v_mfma_f32_16x16x32_f16 v[64:67], a[28:31], a[32:35], v[64:67]
    ds_read_b64 a[56:57], v62 offset:832
    ds_read_b64 a[58:59], v62 offset:840
    v_mfma_f32_16x16x32_f16 v[76:79], a[20:23], v[42:45], 0
    s_waitcnt lgkmcnt(8)
    ds_read_b128 a[60:63], v37 offset:288
    ds_read_b64 a[64:65], v62 offset:320
    v_mfma_f32_16x16x32_f16 v[68:71], a[36:39], a[32:35], v[68:71]
    s_waitcnt lgkmcnt(7)
    ds_read_b64 a[66:67], v62 offset:328
    ds_read_b64 a[68:69], v62 offset:896
    v_mfma_f32_16x16x32_f16 v[64:67], a[40:43], a[44:47], v[64:67]
    s_waitcnt lgkmcnt(8)
    ds_read_b64 a[70:71], v62 offset:904
    ds_read_b128 a[72:75], v37 offset:352
    v_mfma_f32_16x16x32_f16 v[86:89], a[48:51], v[38:41], 0
    s_waitcnt lgkmcnt(8)
    v_cvt_pk_f16_f32 v90, v72, v73
    v_cvt_pk_f16_f32 v91, v74, v75
    v_mfma_f32_16x16x32_f16 v[68:71], a[52:55], a[44:47], v[68:71]
    s_waitcnt lgkmcnt(5)
    ds_read_b64 a[76:77], v62 offset:384
    ds_read_b64 a[78:79], v62 offset:392
    v_mfma_f32_16x16x32_f16 v[64:67], a[56:59], a[60:63], v[64:67]
    ds_read_b64 a[80:81], v62 offset:960
    ds_read_b64 a[82:83], v62 offset:968
    v_mfma_f32_16x16x32_f16 v[94:97], a[48:51], v[42:45], 0
    s_waitcnt lgkmcnt(7)
    ds_read_b128 a[84:87], v37 offset:416
    v_cvt_pk_f16_f32 v92, v76, v77
    v_mfma_f32_16x16x32_f16 v[68:71], a[64:67], a[60:63], v[68:71]
    s_waitcnt lgkmcnt(5)
    ds_read_b64 a[88:89], v62 offset:448
    v_cvt_pk_f16_f32 v93, v78, v79
    v_mfma_f32_16x16x32_f16 v[64:67], a[68:71], a[72:75], v[64:67]
    ds_read_b64 a[90:91], v62 offset:456
    ds_read_b64 a[92:93], v62 offset:1024
    v_mfma_f32_16x16x32_f16 v[98:101], a[20:23], v[46:49], 0
    s_waitcnt lgkmcnt(6)
    ds_read_b64 a[94:95], v62 offset:1032
    ds_read_b128 a[96:99], v37 offset:480
    v_mfma_f32_16x16x32_f16 v[68:71], a[76:79], a[72:75], v[68:71]
    s_waitcnt lgkmcnt(5)
    ds_read_b64 a[100:101], v62 offset:1120
    ds_read_b64 a[102:103], v62 offset:1128
    v_cvt_pk_f16_f32 v102, v86, v87
    v_cvt_pk_f16_f32 v103, v88, v89
    v_mfma_f32_16x16x32_f16 v[64:67], a[80:83], a[84:87], v[64:67]
    ds_read_b64 a[104:105], v62 offset:512
    ds_read_b64 a[106:107], v62 offset:520
    v_mfma_f32_16x16x32_f16 v[106:109], a[48:51], v[50:53], 0
    s_waitcnt lgkmcnt(7)
    ds_read_b64 a[108:109], v62 offset:0
    ds_read_b64 a[110:111], v62 offset:8
    v_mfma_f32_16x16x32_f16 v[68:71], a[88:91], a[84:87], v[68:71]
    s_waitcnt lgkmcnt(6)
    ds_read_b128 a[112:115], v37 offset:544
    v_cvt_pk_f16_f32 v104, v94, v95
    v_cvt_pk_f16_f32 v105, v96, v97
    v_mfma_f32_16x16x32_f16 v[64:67], a[92:95], a[96:99], v[64:67]
    s_waitcnt lgkmcnt(5)
    ds_read_b64 a[116:117], v63 offset:1280
    ds_read_b64 a[118:119], v63 offset:1376
    v_mfma_f32_16x16x32_f16 v[110:113], a[100:103], a[20:23], 0
    s_waitcnt lgkmcnt(5)
    v_cvt_pk_f16_f32 v72, v98, v99
    v_cvt_pk_f16_f32 v73, v100, v101
    v_mfma_f32_16x16x32_f16 v[68:71], a[104:107], a[96:99], v[68:71]
    s_waitcnt lgkmcnt(3)
    ds_read_b128 a[120:123], v37 offset:608
    global_load_dword v5, v18, s[8:9]
    v_mfma_f32_16x16x32_f16 v[76:79], a[108:111], a[96:99], 0
    s_waitcnt lgkmcnt(3)
    ds_read_b64 a[124:125], v63 offset:1248
    ds_read_b64 a[126:127], v63 offset:1344
    v_mfma_f32_16x16x32_f16 v[68:71], a[0:3], a[112:115], v[68:71]
    s_waitcnt lgkmcnt(3)
    v_cvt_pk_f16_f32 v74, v106, v107
    v_cvt_pk_f16_f32 v75, v108, v109
    v_mfma_f32_16x16x32_f16 v[76:79], v[90:93], a[116:119], v[76:79]
    ds_read_b128 a[128:131], v37 offset:672
    ds_read_b64 a[132:133], v63 offset:1216
    v_mfma_f32_16x16x32_f16 v[76:79], a[8:11], a[112:115], v[76:79]
    s_waitcnt lgkmcnt(4)
    ds_read_b64 a[134:135], v63 offset:1312
    ds_read_b128 a[136:139], v37 offset:736
    v_mfma_f32_16x16x32_f16 v[68:71], a[12:15], a[120:123], v[68:71]
    s_waitcnt lgkmcnt(4)
    ds_read_b64 a[4:5], v63 offset:1472
    ds_read_b64 a[6:7], v63 offset:1568
    v_mfma_f32_16x16x32_f16 v[86:89], v[90:93], a[124:127], 0
    ds_read_b128 a[16:19], v37 offset:800
    ds_read_b64 a[32:33], v63 offset:1440
    v_mfma_f32_16x16x32_f16 v[76:79], a[24:27], a[120:123], v[76:79]
    s_waitcnt lgkmcnt(7)
    ds_read_b64 a[34:35], v63 offset:1536
    v_mul_f32 v30, v64, v6
    v_mfma_f32_16x16x32_f16 v[68:71], a[28:31], a[128:131], v[68:71]
    s_waitcnt lgkmcnt(6)
    v_mul_f32 v31, v65, v6
    v_mul_f32 v32, v66, v6
    v_mfma_f32_16x16x32_f16 v[110:113], v[90:93], a[132:135], v[110:113]
    v_mul_f32 v33, v67, v6
    v_cvt_pk_bf16_f32 v34, v30, v31
    v_mfma_f32_16x16x32_f16 v[76:79], a[36:39], a[128:131], v[76:79]
    s_waitcnt lgkmcnt(5)
    v_cvt_pk_bf16_f32 v35, v32, v33
    ds_write_b64 v60, v[34:35] offset:26368
    v_mfma_f32_16x16x32_f16 v[68:71], a[40:43], a[136:139], v[68:71]
    s_waitcnt lgkmcnt(4)
    ds_read_b128 a[44:47], v37 offset:864
    ds_read_b64 a[60:61], v63 offset:1408
    v_mfma_f32_16x16x32_f16 v[76:79], v[102:105], a[4:7], v[76:79]
    ds_read_b64 a[62:63], v63 offset:1504
    ds_read_b128 a[72:75], v37 offset:928
    v_mfma_f32_16x16x32_f16 v[76:79], a[52:55], a[136:139], v[76:79]
    s_waitcnt lgkmcnt(7)
    ds_read_b64 a[48:49], v63 offset:1728
    ds_read_b64 a[50:51], v63 offset:1888
    v_mfma_f32_16x16x32_f16 v[68:71], a[56:59], a[16:19], v[68:71]
    s_waitcnt lgkmcnt(7)
    ds_read_b128 a[84:87], v37 offset:992
    ds_read_b128 a[100:103], v37 offset:992
    v_mfma_f32_16x16x32_f16 v[86:89], v[102:105], a[32:35], v[86:89]
    ds_read_b128 a[20:23], v37 offset:1056
    ds_read_b128 a[96:99], v37 offset:1120
    v_mfma_f32_16x16x32_f16 v[76:79], a[64:67], a[16:19], v[76:79]
    s_waitcnt lgkmcnt(9)
    ds_read_b128 a[112:115], v37 offset:976
    v_mfma_f32_16x16x32_f16 v[68:71], a[68:71], a[44:47], v[68:71]
    s_waitcnt lgkmcnt(8)
    ds_read_b128 a[120:123], v37 offset:1184
    v_mfma_f32_16x16x32_f16 v[110:113], v[102:105], a[60:63], v[110:113]
    v_mfma_f32_16x16x32_f16 v[76:79], a[76:79], a[44:47], v[76:79]
    s_waitcnt lgkmcnt(8)
    v_mfma_f32_16x16x32_f16 v[68:71], a[80:83], a[72:75], v[68:71]
    s_waitcnt lgkmcnt(6)
    ds_read_b128 a[132:135], v37 offset:1248
    v_mfma_f32_16x16x32_f16 v[110:113], v[72:75], a[48:51], v[110:113]
    v_mfma_f32_16x16x32_f16 v[76:79], a[88:91], a[72:75], v[76:79]
    s_waitcnt lgkmcnt(6)
    v_mfma_f32_16x16x32_f16 v[68:71], a[92:95], a[84:87], v[68:71]
    ds_read_b128 a[128:131], v37 offset:1312
    v_mfma_f32_16x16x32_f16 v[76:79], a[104:107], a[84:87], v[76:79]
    s_waitcnt lgkmcnt(6)
    v_mfma_f32_16x16x32_f16 v[94:97], a[100:103], v[38:41], 0
    v_mfma_f32_16x16x32_f16 v[86:89], a[108:111], a[84:87], v[86:89]
    s_waitcnt lgkmcnt(5)
    ds_read_b128 a[136:139], v37 offset:1376
    v_mfma_f32_16x16x32_f16 v[76:79], a[0:3], a[20:23], v[76:79]
    v_mul_f32 v30, v68, v6
    v_mul_f32 v31, v69, v6
    v_mfma_f32_16x16x32_f16 v[98:101], a[100:103], v[42:45], 0
    v_mul_f32 v32, v70, v6
    v_mul_f32 v33, v71, v6
    v_mfma_f32_16x16x32_f16 v[86:89], a[8:11], a[20:23], v[86:89]
    s_waitcnt lgkmcnt(5)
    v_cvt_pk_f16_f32 v106, v94, v95
    v_cvt_pk_f16_f32 v107, v96, v97
    v_mfma_f32_16x16x32_f16 v[76:79], a[12:15], a[96:99], v[76:79]
    s_waitcnt lgkmcnt(4)
    v_cvt_pk_bf16_f32 v34, v30, v31
    v_cvt_pk_bf16_f32 v35, v32, v33
    v_mfma_f32_16x16x32_f16 v[90:93], a[112:115], v[38:41], 0
    ds_write_b64 v60, v[34:35] offset:27392
    ds_read_b128 a[16:19], v37 offset:1440
    v_mfma_f32_16x16x32_f16 v[86:89], a[24:27], a[96:99], v[86:89]
    s_waitcnt lgkmcnt(5)
    v_cvt_pk_f16_f32 v108, v98, v99
    v_cvt_pk_f16_f32 v109, v100, v101
    v_mfma_f32_16x16x32_f16 v[76:79], a[28:31], a[120:123], v[76:79]
    ds_read_b128 a[60:63], v37 offset:1504
    v_mfma_f32_16x16x32_f16 v[64:67], a[112:115], v[42:45], 0
    ds_read_b128 a[44:47], v37 offset:1504
    v_mfma_f32_16x16x32_f16 v[86:89], a[36:39], a[120:123], v[86:89]
    s_waitcnt lgkmcnt(6)
    v_cvt_pk_f16_f32 v102, v90, v91
    v_cvt_pk_f16_f32 v103, v92, v93
    v_mfma_f32_16x16x32_f16 v[76:79], a[40:43], a[132:135], v[76:79]
    ds_read_b128 a[48:51], v37 offset:1568
    v_mfma_f32_16x16x32_f16 v[86:89], v[106:109], a[116:119], v[86:89]
    v_mfma_f32_16x16x32_f16 v[86:89], a[52:55], a[132:135], v[86:89]
    s_waitcnt lgkmcnt(6)
    v_cvt_pk_f16_f32 v104, v64, v65
    v_cvt_pk_f16_f32 v105, v66, v67
    v_mfma_f32_16x16x32_f16 v[76:79], a[56:59], a[128:131], v[76:79]
    ds_read_b128 a[72:75], v37 offset:1632
    v_mfma_f32_16x16x32_f16 v[110:113], v[106:109], a[124:127], v[110:113]
    ds_read_b128 a[84:87], v37 offset:1488
    v_mfma_f32_16x16x32_f16 v[86:89], a[64:67], a[128:131], v[86:89]
    s_waitcnt lgkmcnt(7)
    v_mfma_f32_16x16x32_f16 v[76:79], a[68:71], a[136:139], v[76:79]
    ds_read_b128 a[100:103], v37 offset:1696
    v_mfma_f32_16x16x32_f16 v[86:89], v[102:105], a[4:7], v[86:89]
    v_mfma_f32_16x16x32_f16 v[86:89], a[76:79], a[136:139], v[86:89]
    s_waitcnt lgkmcnt(6)
    v_mfma_f32_16x16x32_f16 v[76:79], a[80:83], a[16:19], v[76:79]
    ds_read_b128 a[20:23], v37 offset:1760
    v_mfma_f32_16x16x32_f16 v[86:89], a[88:91], a[16:19], v[86:89]
    v_mfma_f32_16x16x32_f16 v[110:113], v[102:105], a[32:35], v[110:113]
    s_waitcnt lgkmcnt(6)
    v_mfma_f32_16x16x32_f16 v[76:79], a[92:95], a[60:63], v[76:79]
    ds_read_b128 a[96:99], v37 offset:1824
    v_mfma_f32_16x16x32_f16 v[86:89], a[104:107], a[60:63], v[86:89]
    s_waitcnt lgkmcnt(6)
    v_mfma_f32_16x16x32_f16 v[72:75], a[44:47], v[38:41], 0
    ds_read_b128 a[112:115], v37 offset:1888
    v_mfma_f32_16x16x32_f16 v[110:113], a[108:111], a[60:63], v[110:113]
    s_waitcnt lgkmcnt(6)
    v_mfma_f32_16x16x32_f16 v[86:89], a[0:3], a[48:51], v[86:89]
    v_mul_f32 v30, v76, v6
    v_mul_f32 v31, v77, v6
    v_mfma_f32_16x16x32_f16 v[68:71], a[44:47], v[42:45], 0
    v_mul_f32 v32, v78, v6
    v_mul_f32 v33, v79, v6
    v_mfma_f32_16x16x32_f16 v[110:113], a[8:11], a[48:51], v[110:113]
    s_waitcnt lgkmcnt(5)
    v_cvt_pk_f16_f32 v94, v72, v73
    v_cvt_pk_f16_f32 v95, v74, v75
    v_mfma_f32_16x16x32_f16 v[86:89], a[12:15], a[72:75], v[86:89]
    s_waitcnt lgkmcnt(4)
    v_cvt_pk_bf16_f32 v34, v30, v31
    v_cvt_pk_bf16_f32 v35, v32, v33
    v_mfma_f32_16x16x32_f16 v[98:101], a[84:87], v[38:41], 0
    ds_write_b64 v60, v[34:35] offset:28416
    ds_read_b128 a[120:123], v37 offset:1952
    v_mfma_f32_16x16x32_f16 v[110:113], a[24:27], a[72:75], v[110:113]
    s_waitcnt lgkmcnt(5)
    v_cvt_pk_f16_f32 v96, v68, v69
    v_cvt_pk_f16_f32 v97, v70, v71
    v_mfma_f32_16x16x32_f16 v[86:89], a[28:31], a[100:103], v[86:89]
    ds_read_b128 a[132:135], v37 offset:2016
    ds_read_b128 a[124:127], v37 offset:2080
    v_mfma_f32_16x16x32_f16 v[90:93], a[84:87], v[42:45], 0
    ds_read_b128 a[128:131], v37 offset:2144
    ds_read_b128 a[136:139], v37 offset:2208
    v_mfma_f32_16x16x32_f16 v[110:113], a[36:39], a[100:103], v[110:113]
    s_waitcnt lgkmcnt(8)
    v_cvt_pk_f16_f32 v64, v98, v99
    v_cvt_pk_f16_f32 v65, v100, v101
    v_mfma_f32_16x16x32_f16 v[86:89], a[40:43], a[20:23], v[86:89]
    ds_read_b128 a[16:19], v37 offset:2272
    ds_read_b128 a[32:35], v37 offset:2336
    v_mfma_f32_16x16x32_f16 v[110:113], v[94:97], a[116:119], v[110:113]
    ds_read_b128 a[60:63], v37 offset:2400
    v_mfma_f32_16x16x32_f16 v[110:113], a[52:55], a[20:23], v[110:113]
    s_waitcnt lgkmcnt(10)
    v_cvt_pk_f16_f32 v66, v90, v91
    v_cvt_pk_f16_f32 v67, v92, v93
    v_mfma_f32_16x16x32_f16 v[86:89], a[56:59], a[96:99], v[86:89]
    ds_read_b128 a[108:111], v37 offset:2464
    ds_read_b128 a[44:47], v37 offset:2528
    v_mfma_f32_16x16x32_f16 v[110:113], a[64:67], a[96:99], v[110:113]
    s_waitcnt lgkmcnt(11)
    v_mfma_f32_16x16x32_f16 v[86:89], a[68:71], a[112:115], v[86:89]
    v_mfma_f32_16x16x32_f16 v[110:113], v[64:67], a[4:7], v[110:113]
    v_mfma_f32_16x16x32_f16 v[110:113], a[76:79], a[112:115], v[110:113]
    s_waitcnt lgkmcnt(9)
    v_mfma_f32_16x16x32_f16 v[86:89], a[80:83], a[120:123], v[86:89]
    v_mfma_f32_16x16x32_f16 v[110:113], a[88:91], a[120:123], v[110:113]
    s_waitcnt lgkmcnt(8)
    v_mfma_f32_16x16x32_f16 v[86:89], a[92:95], a[132:135], v[86:89]
    v_mfma_f32_16x16x32_f16 v[110:113], a[104:107], a[132:135], v[110:113]
    s_waitcnt lgkmcnt(7)
    v_mfma_f32_16x16x32_f16 v[110:113], a[0:3], a[124:127], v[110:113]
    s_waitcnt lgkmcnt(6)
    v_mfma_f32_16x16x32_f16 v[110:113], a[12:15], a[128:131], v[110:113]
    s_waitcnt lgkmcnt(5)
    v_mfma_f32_16x16x32_f16 v[110:113], a[28:31], a[136:139], v[110:113]
    s_waitcnt lgkmcnt(4)
    v_mul_f32 v30, v86, v6
    v_mul_f32 v31, v87, v6
    v_mfma_f32_16x16x32_f16 v[110:113], a[40:43], a[16:19], v[110:113]
    s_waitcnt lgkmcnt(3)
    v_mul_f32 v32, v88, v6
    v_mul_f32 v33, v89, v6
    v_mfma_f32_16x16x32_f16 v[110:113], a[56:59], a[32:35], v[110:113]
    s_waitcnt lgkmcnt(2)
    v_cvt_pk_bf16_f32 v34, v30, v31
    v_cvt_pk_bf16_f32 v35, v32, v33
    v_mfma_f32_16x16x32_f16 v[110:113], a[68:71], a[60:63], v[110:113]
    s_waitcnt lgkmcnt(1)
    ds_write_b64 v60, v[34:35] offset:29440
    v_mfma_f32_16x16x32_f16 v[110:113], a[80:83], a[108:111], v[110:113]
    s_waitcnt lgkmcnt(1)
    v_mfma_f32_16x16x32_f16 v[110:113], a[92:95], a[44:47], v[110:113]
    s_nop 7
    v_mul_f32 v30, v110, v6
    v_mul_f32 v31, v111, v6
    v_mul_f32 v32, v112, v6
    v_mul_f32 v33, v113, v6
    v_cvt_pk_bf16_f32 v34, v30, v31
    v_cvt_pk_bf16_f32 v35, v32, v33
    ds_write_b64 v60, v[34:35] offset:30464
    s_waitcnt lgkmcnt(0)
    s_nop 0
    s_branch L_conv_done
.p2alignl 12, 0xbf810000
L_conv_b:
    s_waitcnt lgkmcnt(0)
    s_barrier
    ds_read_b64 a[0:1], v62 offset:0
    ds_read_b64 a[2:3], v62 offset:8
    ds_read_b128 a[4:7], v37 offset:2016
    ds_read_b128 a[8:11], v37 offset:480
    ds_read_b64 a[12:13], v62 offset:64
    ds_read_b64 a[14:15], v62 offset:72
    ds_read_b128 a[16:19], v37 offset:2080
    ds_read_b128 a[20:23], v37 offset:464
    s_waitcnt lgkmcnt(5)
    v_mfma_f32_16x16x32_f16 v[64:67], a[0:3], a[4:7], 0
    s_waitcnt lgkmcnt(4)
    ds_read_b64 a[24:25], v62 offset:128
    ds_read_b64 a[26:27], v62 offset:136
    ds_read_b128 a[28:31], v37 offset:2144
    ds_read_b128 a[32:35], v37 offset:992
    v_mfma_f32_16x16x32_f16 v[68:71], a[8:11], v[46:49], 0
    s_waitcnt lgkmcnt(5)
    ds_read_b64 a[36:37], v62 offset:192
    ds_read_b64 a[38:39], v62 offset:200
    ds_read_b128 a[40:43], v37 offset:2208
    v_mfma_f32_16x16x32_f16 v[64:67], a[12:15], a[16:19], v[64:67]
    s_waitcnt lgkmcnt(7)
    ds_read_b64 a[44:45], v62 offset:256
    ds_read_b64 a[46:47], v62 offset:264
    v_mfma_f32_16x16x32_f16 v[72:75], a[20:23], v[50:53], 0
    s_waitcnt lgkmcnt(6)
    ds_read_b128 a[48:51], v37 offset:2272
    ds_read_b128 a[52:55], v37 offset:976
    v_mfma_f32_16x16x32_f16 v[64:67], a[24:27], a[28:31], v[64:67]
    s_waitcnt lgkmcnt(7)
    ds_read_b64 a[56:57], v62 offset:320
    ds_read_b64 a[58:59], v62 offset:328
    v_mfma_f32_16x16x32_f16 v[76:79], a[32:35], v[38:41], 0
    s_waitcnt lgkmcnt(6)
    ds_read_b128 a[60:63], v37 offset:2336
    ds_read_b64 a[64:65], v63 offset:1696
    v_mfma_f32_16x16x32_f16 v[64:67], a[36:39], a[40:43], v[64:67]
    ds_read_b64 a[66:67], v63 offset:1856
    v_cvt_pk_f16_f32 v86, v68, v69
    v_mfma_f32_16x16x32_f16 v[90:93], a[32:35], v[42:45], 0
    s_waitcnt lgkmcnt(6)
    ds_read_b64 a[68:69], v62 offset:384
    v_cvt_pk_f16_f32 v87, v70, v71
    v_mfma_f32_16x16x32_f16 v[64:67], a[44:47], a[48:51], v[64:67]
    s_waitcnt lgkmcnt(6)
    ds_read_b64 a[70:71], v62 offset:392
    ds_read_b128 a[72:75], v37 offset:2400
    v_mfma_f32_16x16x32_f16 v[94:97], a[52:55], v[38:41], 0
    ds_read_b64 a[76:77], v63 offset:1664
    ds_read_b64 a[78:79], v63 offset:1824
    v_mfma_f32_16x16x32_f16 v[98:101], a[52:55], v[42:45], 0
    s_waitcnt lgkmcnt(7)
    ds_read_b64 a[80:81], v62 offset:448
    ds_read_b64 a[82:83], v62 offset:456
    ds_read_b128 a[84:87], v37 offset:2464
    v_cvt_pk_f16_f32 v88, v72, v73
    v_cvt_pk_f16_f32 v89, v74, v75
    v_mfma_f32_16x16x32_f16 v[64:67], a[56:59], a[60:63], v[64:67]
    s_waitcnt lgkmcnt(8)
    ds_read_b64 a[88:89], v63 offset:1632
    ds_read_b64 a[90:91], v63 offset:1792
    v_mfma_f32_16x16x32_f16 v[64:67], v[86:89], a[64:67], v[64:67]
    s_waitcnt lgkmcnt(7)
    ds_read_b64 a[92:93], v62 offset:512
    ds_read_b64 a[94:95], v62 offset:520
    ds_read_b128 a[96:99], v37 offset:2528
    v_cvt_pk_f16_f32 v102, v76, v77
    v_cvt_pk_f16_f32 v103, v78, v79
    v_mfma_f32_16x16x32_f16 v[64:67], a[68:71], a[72:75], v[64:67]
    s_waitcnt lgkmcnt(8)
    v_cvt_pk_f16_f32 v104, v90, v91
    v_cvt_pk_f16_f32 v105, v92, v93
    v_mfma_f32_16x16x32_f16 v[106:109], v[86:89], a[76:79], 0
    s_waitcnt lgkmcnt(5)
    v_cvt_pk_f16_f32 v110, v94, v95
    v_cvt_pk_f16_f32 v111, v96, v97
    v_mfma_f32_16x16x32_f16 v[64:67], a[80:83], a[84:87], v[64:67]
    s_waitcnt lgkmcnt(3)
    ds_read_b64 a[100:101], v62 offset:1120
    ds_read_b64 a[102:103], v62 offset:1128
    v_mfma_f32_16x16x32_f16 v[68:71], v[86:89], a[88:91], 0
    s_waitcnt lgkmcnt(2)
    v_cvt_pk_f16_f32 v112, v98, v99
    v_cvt_pk_f16_f32 v113, v100, v101
    v_mfma_f32_16x16x32_f16 v[64:67], a[92:95], a[96:99], v[64:67]
    ds_read_b64 a[104:105], v62 offset:576
    ds_read_b64 a[106:107], v62 offset:584
    ds_read_b128 a[108:111], v37 offset:2592
    v_mfma_f32_16x16x32_f16 v[72:75], a[32:35], v[46:49], 0
    ds_read_b64 a[112:113], v63 offset:1216
    ds_read_b64 a[114:115], v63 offset:1312
    v_mfma_f32_16x16x32_f16 v[106:109], a[0:3], a[96:99], v[106:109]
    ds_read_b64 a[116:117], v63 offset:1408
    ds_read_b64 a[118:119], v63 offset:1504
    v_mfma_f32_16x16x32_f16 v[76:79], a[52:55], v[50:53], 0
    s_waitcnt lgkmcnt(7)
    ds_read_b64 a[120:121], v62 offset:640
    ds_read_b64 a[122:123], v62 offset:648
    v_mfma_f32_16x16x32_f16 v[64:67], a[100:103], a[32:35], v[64:67]
    s_waitcnt lgkmcnt(6)
    ds_read_b128 a[124:127], v37 offset:2656
    ds_read_b128 a[128:131], v37 offset:1504
    v_mfma_f32_16x16x32_f16 v[64:67], a[104:107], a[108:111], v[64:67]
    s_waitcnt lgkmcnt(6)
    global_load_dword v5, v18, s[8:9]
    ds_read_b64 a[132:133], v63 offset:1728
    v_mfma_f32_16x16x32_f16 v[64:67], v[102:105], a[112:115], v[64:67]
    ds_read_b64 a[134:135], v63 offset:1888
    v_cvt_pk_f16_f32 v90, v72, v73
    v_mfma_f32_16x16x32_f16 v[106:109], a[12:15], a[108:111], v[106:109]
    s_waitcnt lgkmcnt(6)
    ds_read_b64 a[136:137], v62 offset:704
    v_cvt_pk_f16_f32 v91, v74, v75
    v_mfma_f32_16x16x32_f16 v[64:67], v[110:113], a[116:119], v[64:67]
    s_waitcnt lgkmcnt(4)
    ds_read_b64 a[138:139], v62 offset:712
    ds_read_b128 a[4:7], v37 offset:2720
    v_mfma_f32_16x16x32_f16 v[64:67], a[120:123], a[124:127], v[64:67]
    s_waitcnt lgkmcnt(5)
    v_cvt_pk_f16_f32 v92, v76, v77
    v_cvt_pk_f16_f32 v93, v78, v79
    v_mfma_f32_16x16x32_f16 v[94:97], a[128:131], v[38:41], 0
    ds_read_b64 a[8:9], v62 offset:768
    ds_read_b64 a[10:11], v62 offset:776
    v_mfma_f32_16x16x32_f16 v[106:109], a[24:27], a[124:127], v[106:109]
    s_waitcnt lgkmcnt(5)
    ds_read_b128 a[16:19], v37 offset:2784
    ds_read_b128 a[20:23], v37 offset:1488
    v_mfma_f32_16x16x32_f16 v[64:67], v[90:93], a[132:135], v[64:67]
    s_waitcnt lgkmcnt(4)
    ds_read_b64 a[28:29], v62 offset:832
    ds_read_b64 a[30:31], v62 offset:840
    v_mfma_f32_16x16x32_f16 v[64:67], a[136:139], a[4:7], v[64:67]
    ds_read_b128 a[40:43], v37 offset:2848
    ds_read_b64 a[48:49], v62 offset:896
    v_mfma_f32_16x16x32_f16 v[106:109], v[90:93], a[64:67], v[106:109]
    v_cvt_pk_f16_f32 v86, v94, v95
    v_cvt_pk_f16_f32 v87, v96, v97
    v_mfma_f32_16x16x32_f16 v[68:71], v[90:93], a[76:79], v[68:71]
    ds_read_b64 a[50:51], v62 offset:904
    ds_read_b128 a[60:63], v37 offset:2912
    v_mfma_f32_16x16x32_f16 v[106:109], a[36:39], a[4:7], v[106:109]
    ds_read_b64 a[72:73], v63 offset:1248
    ds_read_b64 a[74:75], v63 offset:1344
    v_mfma_f32_16x16x32_f16 v[98:101], a[128:131], v[42:45], 0
    s_waitcnt lgkmcnt(9)
    ds_read_b64 a[84:85], v62 offset:960
    ds_read_b64 a[86:87], v62 offset:968
    v_mfma_f32_16x16x32_f16 v[64:67], a[8:11], a[16:19], v[64:67]
    s_waitcnt lgkmcnt(10)
    ds_read_b128 a[88:91], v37 offset:2976
    ds_read_b64 a[96:97], v63 offset:1440
    v_mfma_f32_16x16x32_f16 v[102:105], a[20:23], v[38:41], 0
    ds_read_b64 a[98:99], v63 offset:1536
    v_mfma_f32_16x16x32_f16 v[106:109], a[44:47], a[16:19], v[106:109]
    v_mfma_f32_16x16x32_f16 v[72:75], a[20:23], v[42:45], 0
    s_waitcnt lgkmcnt(10)
    v_cvt_pk_f16_f32 v88, v98, v99
    v_cvt_pk_f16_f32 v89, v100, v101
    v_mfma_f32_16x16x32_f16 v[64:67], a[28:31], a[40:43], v[64:67]
    ds_read_b128 a[52:55], v37 offset:2016
    v_mfma_f32_16x16x32_f16 v[110:113], a[128:131], v[46:49], 0
    v_cvt_pk_f16_f32 v76, v102, v103
    v_cvt_pk_f16_f32 v77, v104, v105
    v_mfma_f32_16x16x32_f16 v[106:109], a[56:59], a[40:43], v[106:109]
    ds_read_b128 a[32:35], v37 offset:2000
    v_mfma_f32_16x16x32_f16 v[94:97], a[20:23], v[50:53], 0
    v_cvt_pk_f16_f32 v78, v72, v73
    v_cvt_pk_f16_f32 v79, v74, v75
    v_mfma_f32_16x16x32_f16 v[106:109], a[100:103], a[128:131], v[106:109]
    s_waitcnt lgkmcnt(9)
    v_mfma_f32_16x16x32_f16 v[64:67], a[48:51], a[60:63], v[64:67]
    s_waitcnt lgkmcnt(7)
    v_cvt_pk_f16_f32 v90, v110, v111
    v_cvt_pk_f16_f32 v91, v112, v113
    v_mfma_f32_16x16x32_f16 v[64:67], v[86:89], a[72:75], v[64:67]
    ds_read_b128 a[108:111], v37 offset:2528
    v_mfma_f32_16x16x32_f16 v[106:109], a[68:71], a[60:63], v[106:109]
    v_cvt_pk_f16_f32 v92, v94, v95
    v_cvt_pk_f16_f32 v93, v96, v97
    v_mfma_f32_16x16x32_f16 v[106:109], v[86:89], a[112:115], v[106:109]
    s_waitcnt lgkmcnt(5)
    ds_read_b64 a[124:125], v63 offset:1280
    ds_read_b64 a[126:127], v63 offset:1376
    v_mfma_f32_16x16x32_f16 v[64:67], a[84:87], a[88:91], v[64:67]
    s_waitcnt lgkmcnt(5)
    v_mfma_f32_16x16x32_f16 v[64:67], v[76:79], a[96:99], v[64:67]
    v_mfma_f32_16x16x32_f16 v[106:109], a[80:83], a[88:91], v[106:109]
    ds_read_b64 a[76:77], v63 offset:1472
    ds_read_b64 a[78:79], v63 offset:1568
    v_mfma_f32_16x16x32_f16 v[106:109], v[76:79], a[116:119], v[106:109]
    ds_read_b64 a[4:5], v62 offset:1024
    ds_read_b64 a[6:7], v62 offset:1032
    v_mfma_f32_16x16x32_f16 v[106:109], v[90:93], a[132:135], v[106:109]
    ds_read_b128 a[16:19], v37 offset:3040
    v_mfma_f32_16x16x32_f16 v[68:71], v[90:93], a[64:67], v[68:71]
    s_waitcnt lgkmcnt(9)
    v_mfma_f32_16x16x32_f16 v[98:101], a[52:55], v[38:41], 0
    ds_read_b128 a[40:43], v37 offset:3104
    v_mfma_f32_16x16x32_f16 v[102:105], a[52:55], v[42:45], 0
    s_waitcnt lgkmcnt(9)
    v_mfma_f32_16x16x32_f16 v[72:75], a[32:35], v[38:41], 0
    ds_read_b128 a[20:23], v37 offset:3168
    v_mfma_f32_16x16x32_f16 v[110:113], a[32:35], v[42:45], 0
    v_mfma_f32_16x16x32_f16 v[94:97], a[52:55], v[46:49], 0
    s_nop 0
    v_cvt_pk_f16_f32 v86, v98, v99
    v_cvt_pk_f16_f32 v87, v100, v101
    v_mfma_f32_16x16x32_f16 v[76:79], a[32:35], v[50:53], 0
    v_cvt_pk_f16_f32 v88, v102, v103
    v_cvt_pk_f16_f32 v89, v104, v105
    v_mfma_f32_16x16x32_f16 v[68:71], a[100:103], a[52:55], v[68:71]
    s_waitcnt lgkmcnt(9)
    v_cvt_pk_f16_f32 v90, v72, v73
    v_cvt_pk_f16_f32 v91, v74, v75
    v_mfma_f32_16x16x32_f16 v[98:101], a[108:111], v[38:41], 0
    v_cvt_pk_f16_f32 v92, v110, v111
    v_cvt_pk_f16_f32 v93, v112, v113
    v_mfma_f32_16x16x32_f16 v[102:105], a[108:111], v[42:45], 0
    s_waitcnt lgkmcnt(7)
    v_cvt_pk_f16_f32 v72, v94, v95
    v_cvt_pk_f16_f32 v73, v96, v97
    v_mfma_f32_16x16x32_f16 v[64:67], v[86:89], a[124:127], v[64:67]
    v_cvt_pk_f16_f32 v74, v76, v77
    v_cvt_pk_f16_f32 v75, v78, v79
    v_mfma_f32_16x16x32_f16 v[106:109], v[86:89], a[72:75], v[106:109]
    ds_read_b128 a[128:131], v37 offset:3232
    ds_read_b128 a[60:63], v37 offset:3296
    v_mfma_f32_16x16x32_f16 v[68:71], v[86:89], a[112:115], v[68:71]
    s_waitcnt lgkmcnt(7)
    v_cvt_pk_f16_f32 v110, v98, v99
    v_cvt_pk_f16_f32 v111, v100, v101
    v_mfma_f32_16x16x32_f16 v[64:67], v[90:93], a[76:79], v[64:67]
    s_waitcnt lgkmcnt(4)
    v_cvt_pk_f16_f32 v112, v102, v103
    v_cvt_pk_f16_f32 v113, v104, v105
    v_mfma_f32_16x16x32_f16 v[64:67], a[4:7], a[16:19], v[64:67]
    ds_read_b128 a[88:91], v37 offset:3360
    ds_read_b128 a[64:67], v37 offset:3424
    v_mfma_f32_16x16x32_f16 v[106:109], a[92:95], a[16:19], v[106:109]
    v_mfma_f32_16x16x32_f16 v[68:71], a[0:3], a[16:19], v[68:71]
    s_waitcnt lgkmcnt(5)
    ds_read_b128 a[32:35], v37 offset:2512
    v_mfma_f32_16x16x32_f16 v[106:109], a[104:107], a[40:43], v[106:109]
    ds_read_b128 a[100:103], v37 offset:3488
    v_mfma_f32_16x16x32_f16 v[68:71], a[12:15], a[40:43], v[68:71]
    s_waitcnt lgkmcnt(6)
    v_mul_f32 v30, v64, v6
    v_mul_f32 v31, v65, v6
    v_mfma_f32_16x16x32_f16 v[106:109], a[120:123], a[20:23], v[106:109]
    v_mul_f32 v32, v66, v6
    v_mul_f32 v33, v67, v6
    v_mfma_f32_16x16x32_f16 v[68:71], a[24:27], a[20:23], v[68:71]
    s_waitcnt lgkmcnt(5)
    v_cvt_pk_bf16_f32 v34, v30, v31
    v_cvt_pk_bf16_f32 v35, v32, v33
    v_mfma_f32_16x16x32_f16 v[106:109], a[136:139], a[128:131], v[106:109]
    ds_write_b64 v60, v[34:35] offset:31488
    v_mfma_f32_16x16x32_f16 v[68:71], a[36:39], a[128:131], v[68:71]
    s_waitcnt lgkmcnt(5)
    ds_read_b128 a[52:55], v37 offset:3040
    v_mfma_f32_16x16x32_f16 v[106:109], a[8:11], a[60:63], v[106:109]
    v_mfma_f32_16x16x32_f16 v[68:71], a[44:47], a[60:63], v[68:71]
    s_waitcnt lgkmcnt(5)
    ds_read_b128 a[108:111], v37 offset:3024
    v_mfma_f32_16x16x32_f16 v[106:109], a[28:31], a[88:91], v[106:109]
    v_mfma_f32_16x16x32_f16 v[68:71], a[56:59], a[88:91], v[68:71]
    v_mfma_f32_16x16x32_f16 v[106:109], v[90:93], a[96:99], v[106:109]
    s_waitcnt lgkmcnt(5)
    ds_read_b128 a[112:115], v37 offset:3552
    v_mfma_f32_16x16x32_f16 v[106:109], a[48:51], a[64:67], v[106:109]
    v_mfma_f32_16x16x32_f16 v[68:71], v[90:93], a[116:119], v[68:71]
    ds_read_b128 a[0:3], v37 offset:3616
    v_mfma_f32_16x16x32_f16 v[68:71], a[68:71], a[64:67], v[68:71]
    ds_read_b128 a[16:19], v37 offset:3680
    v_mfma_f32_16x16x32_f16 v[68:71], v[72:75], a[132:135], v[68:71]
    s_waitcnt lgkmcnt(7)
    ds_read_b128 a[40:43], v37 offset:3744
    v_mfma_f32_16x16x32_f16 v[94:97], a[32:35], v[38:41], 0
    s_waitcnt lgkmcnt(7)
    ds_read_b128 a[12:15], v37 offset:3808
    v_mfma_f32_16x16x32_f16 v[106:109], a[84:87], a[100:103], v[106:109]
    v_mfma_f32_16x16x32_f16 v[76:79], a[32:35], v[42:45], 0
    ds_read_b128 a[24:27], v37 offset:3872
    v_mfma_f32_16x16x32_f16 v[68:71], a[80:83], a[100:103], v[68:71]
    v_mfma_f32_16x16x32_f16 v[106:109], v[110:113], a[124:127], v[106:109]
    s_nop 0
    v_cvt_pk_f16_f32 v86, v94, v95
    v_cvt_pk_f16_f32 v87, v96, v97
    v_mfma_f32_16x16x32_f16 v[68:71], v[110:113], a[72:75], v[68:71]
    s_waitcnt lgkmcnt(7)
    ds_read_b128 a[20:23], v37 offset:3936
    v_mfma_f32_16x16x32_f16 v[98:101], a[52:55], v[38:41], 0
    v_cvt_pk_f16_f32 v88, v76, v77
    v_cvt_pk_f16_f32 v89, v78, v79
    v_mfma_f32_16x16x32_f16 v[102:105], a[52:55], v[42:45], 0
    s_waitcnt lgkmcnt(7)
    ds_read_b128 a[128:131], v37 offset:4000
    ds_read_b128 a[36:39], v37 offset:4064
    v_mfma_f32_16x16x32_f16 v[64:67], a[108:111], v[38:41], 0
    v_mfma_f32_16x16x32_f16 v[90:93], a[108:111], v[42:45], 0
    v_mfma_f32_16x16x32_f16 v[106:109], v[86:89], a[76:79], v[106:109]
    s_waitcnt lgkmcnt(8)
    v_cvt_pk_f16_f32 v72, v98, v99
    v_cvt_pk_f16_f32 v73, v100, v101
    v_mfma_f32_16x16x32_f16 v[106:109], a[4:7], a[112:115], v[106:109]
    v_cvt_pk_f16_f32 v74, v102, v103
    v_cvt_pk_f16_f32 v75, v104, v105
    v_mfma_f32_16x16x32_f16 v[68:71], a[92:95], a[112:115], v[68:71]
    s_waitcnt lgkmcnt(7)
    v_cvt_pk_f16_f32 v94, v64, v65
    v_cvt_pk_f16_f32 v95, v66, v67
    v_mfma_f32_16x16x32_f16 v[68:71], a[104:107], a[0:3], v[68:71]
    s_waitcnt lgkmcnt(6)
    v_cvt_pk_f16_f32 v96, v90, v91
    v_cvt_pk_f16_f32 v97, v92, v93
    v_mfma_f32_16x16x32_f16 v[68:71], a[120:123], a[16:19], v[68:71]
    s_waitcnt lgkmcnt(5)
    v_mfma_f32_16x16x32_f16 v[68:71], a[136:139], a[40:43], v[68:71]
    s_waitcnt lgkmcnt(4)
    v_mul_f32 v30, v106, v6
    v_mul_f32 v31, v107, v6
    v_mfma_f32_16x16x32_f16 v[68:71], a[8:11], a[12:15], v[68:71]
    v_mul_f32 v32, v108, v6
    v_mul_f32 v33, v109, v6
    v_mfma_f32_16x16x32_f16 v[68:71], v[86:89], a[96:99], v[68:71]
    s_waitcnt lgkmcnt(3)
    v_cvt_pk_bf16_f32 v34, v30, v31
    v_cvt_pk_bf16_f32 v35, v32, v33
    v_mfma_f32_16x16x32_f16 v[68:71], a[28:31], a[24:27], v[68:71]
    ds_write_b64 v60, v[34:35] offset:32512
    v_mfma_f32_16x16x32_f16 v[68:71], v[72:75], a[124:127], v[68:71]
    s_waitcnt lgkmcnt(3)
    v_mfma_f32_16x16x32_f16 v[68:71], a[48:51], a[20:23], v[68:71]
    v_mfma_f32_16x16x32_f16 v[68:71], v[94:97], a[76:79], v[68:71]
    s_waitcnt lgkmcnt(2)
    v_mfma_f32_16x16x32_f16 v[68:71], a[84:87], a[128:131], v[68:71]
    s_waitcnt lgkmcnt(1)
    v_mfma_f32_16x16x32_f16 v[68:71], a[4:7], a[36:39], v[68:71]
    s_nop 7
    v_mul_f32 v30, v68, v6
    v_mul_f32 v31, v69, v6
    v_mul_f32 v32, v70, v6
    v_mul_f32 v33, v71, v6
    v_cvt_pk_bf16_f32 v34, v30, v31
    v_cvt_pk_bf16_f32 v35, v32, v33
    ds_write_b64 v60, v[34:35] offset:33536
    s_waitcnt lgkmcnt(0)
    s_nop 0
L_conv_done:
    s_barrier
    ds_read_b128 v[30:33], v16 offset:26368
    ds_read_b128 v[34:37], v16 offset:30464
    s_waitcnt lgkmcnt(1)
    global_store_dwordx4 v12, v[30:33], s[30:31] sc1
    s_waitcnt lgkmcnt(0)
    global_store_dwordx4 v13, v[34:37], s[30:31] sc1
    ds_read2st64_b32 v[38:39], v29 offset0:0 offset1:4
    ds_read2st64_b32 v[40:41], v29 offset0:8 offset1:12
    ds_read2st64_b32 v[42:43], v29 offset0:16 offset1:20
    ds_read2st64_b32 v[44:45], v29 offset0:24 offset1:28
    s_waitcnt lgkmcnt(3)
    v_lshlrev_b32 v46, 16, v38
    v_and_b32 v60, 0xffff0000, v38
    v_lshlrev_b32 v47, 16, v39
    v_and_b32 v61, 0xffff0000, v39
    s_waitcnt lgkmcnt(2)
    v_lshlrev_b32 v48, 16, v40
    v_and_b32 v62, 0xffff0000, v40
    v_lshlrev_b32 v49, 16, v41
    v_and_b32 v63, 0xffff0000, v41
    s_waitcnt lgkmcnt(1)
    v_lshlrev_b32 v50, 16, v42
    v_and_b32 v64, 0xffff0000, v42
    v_lshlrev_b32 v51, 16, v43
    v_and_b32 v65, 0xffff0000, v43
    s_waitcnt lgkmcnt(0)
    v_lshlrev_b32 v52, 16, v44
    v_and_b32 v66, 0xffff0000, v44
    v_lshlrev_b32 v53, 16, v45
    v_and_b32 v67, 0xffff0000, v45
    v_lshlrev_b32 v6, 16, v11
    v_and_b32 v10, 0xffff0000, v11
    v_mul_f32 v6, 0x41800000, v6
    v_mul_f32 v10, 0x41800000, v10
    v_and_b32 v56, v56, v28
    v_and_b32 v57, v57, v28
    v_and_b32 v58, v58, v28
    v_and_b32 v59, v59, v28
    v_fma_mix_f32 v68, v56, v6, 0 op_sel:[0,0,0] op_sel_hi:[1,0,0]
    v_fma_mix_f32 v69, v56, v6, 0 op_sel:[1,0,0] op_sel_hi:[1,0,0]
    v_fma_mix_f32 v70, v57, v6, 0 op_sel:[0,0,0] op_sel_hi:[1,0,0]
    v_fma_mix_f32 v71, v57, v6, 0 op_sel:[1,0,0] op_sel_hi:[1,0,0]
    v_fma_mix_f32 v72, v58, v6, 0 op_sel:[0,0,0] op_sel_hi:[1,0,0]
    v_fma_mix_f32 v73, v58, v6, 0 op_sel:[1,0,0] op_sel_hi:[1,0,0]
    v_fma_mix_f32 v74, v59, v6, 0 op_sel:[0,0,0] op_sel_hi:[1,0,0]
    v_fma_mix_f32 v75, v59, v6, 0 op_sel:[1,0,0] op_sel_hi:[1,0,0]
    v_cvt_pk_bf16_f32 v68, 0, v68
    v_cvt_pk_bf16_f32 v69, 0, v69
    v_cvt_pk_bf16_f32 v70, 0, v70
    v_cvt_pk_bf16_f32 v71, 0, v71
    v_cvt_pk_bf16_f32 v72, 0, v72
    v_cvt_pk_bf16_f32 v73, 0, v73
    v_cvt_pk_bf16_f32 v74, 0, v74
    v_cvt_pk_bf16_f32 v75, 0, v75
    v_and_b32 v82, v82, v28
    v_and_b32 v83, v83, v28
    v_and_b32 v84, v84, v28
    v_and_b32 v85, v85, v28
    v_fma_mix_f32 v76, v82, v10, 0 op_sel:[0,0,0] op_sel_hi:[1,0,0]
    v_fma_mix_f32 v77, v82, v10, 0 op_sel:[1,0,0] op_sel_hi:[1,0,0]
    v_fma_mix_f32 v78, v83, v10, 0 op_sel:[0,0,0] op_sel_hi:[1,0,0]
    v_fma_mix_f32 v79, v83, v10, 0 op_sel:[1,0,0] op_sel_hi:[1,0,0]
    v_fma_mix_f32 v86, v84, v10, 0 op_sel:[0,0,0] op_sel_hi:[1,0,0]
    v_fma_mix_f32 v87, v84, v10, 0 op_sel:[1,0,0] op_sel_hi:[1,0,0]
    v_fma_mix_f32 v88, v85, v10, 0 op_sel:[0,0,0] op_sel_hi:[1,0,0]
    v_fma_mix_f32 v89, v85, v10, 0 op_sel:[1,0,0] op_sel_hi:[1,0,0]
    v_cvt_pk_bf16_f32 v76, 0, v76
    v_cvt_pk_bf16_f32 v77, 0, v77
    v_cvt_pk_bf16_f32 v78, 0, v78
    v_cvt_pk_bf16_f32 v79, 0, v79
    v_cvt_pk_bf16_f32 v86, 0, v86
    v_cvt_pk_bf16_f32 v87, 0, v87
    v_cvt_pk_bf16_f32 v88, 0, v88
    v_cvt_pk_bf16_f32 v89, 0, v89
    v_dot2_f32_bf16 v13, v20, s36, 0
    v_dot2_f32_bf16 v13, v21, s36, v13
    v_dot2_f32_bf16 v13, v22, s36, v13
    v_dot2_f32_bf16 v13, v23, s36, v13
    v_dot2_f32_bf16 v13, v24, s36, v13
    v_dot2_f32_bf16 v13, v25, s36, v13
    v_dot2_f32_bf16 v13, v26, s36, v13
    v_dot2_f32_bf16 v13, v27, s36, v13
    s_nop 2
    v_add_f32_dpp v13, v13, v13 quad_perm:[1,0,3,2] row_mask:0xf bank_mask:0xf
    s_nop 1
    v_add_f32_dpp v13, v13, v13 quad_perm:[2,3,0,1] row_mask:0xf bank_mask:0xf
    s_nop 1
    v_add_f32_dpp v13, v13, v13 row_half_mirror row_mask:0xf bank_mask:0xf
    s_nop 1
    v_add_f32_dpp v13, v13, v13 row_mirror row_mask:0xf bank_mask:0xf
    v_mov_b32 v11, v13
    s_nop 1
    v_permlane16_swap_b32 v13, v11
    v_add_f32 v13, v13, v11
    v_and_b32 v6, 31, v0
    v_lshlrev_b32 v6, 4, v6
    v_lshlrev_b32 v16, 2, v7
    s_lshl_b32 s3, s33, 13
    s_lshl_b32 s16, s32, 4
    s_add_u32 s3, s3, s16
    s_add_u32 s3, s3, 32768
    v_lshl_add_u32 v17, v1, 12, s3
    s_lshr_b32 s3, s32, 5
    s_lshl_b32 s3, s3, 12
    s_add_u32 s16, s3, 32768
    v_lshl_add_u32 v19, v0, 4, s16
    s_lshl_b32 s16, s32, 11
    s_add_u32 s16, s16, 131072
    v_add_u32 v18, s16, v6
    s_lshl_b32 s3, s32, 3
    s_sub_u32 s3, 2047, s3
    v_sub_u32 v12, s3, v7
    v_mov_b32 v10, 0
    s_branch L_pad_dma
.p2alignl 12, 0xbf810000
L_pad_dma:
    s_waitcnt vmcnt(0)
    global_load_dwordx4 v[30:33], v14, s[30:31] sc1
    global_load_dwordx4 v[34:37], v15, s[30:31] sc1
    s_waitcnt vmcnt(1)
    v_max3_u32 v6, v30, v31, v32
    s_waitcnt vmcnt(0)
    v_max3_u32 v6, v6, v33, v34
    v_max3_u32 v6, v6, v35, v36
    v_max3_u32 v6, v6, v37, v37
    v_cmp_eq_u32 vcc, -1, v6
    s_cbranch_vccnz L_s2_slow
L_s2_ok:
    v_dot2_f32_bf16 v98, v30, s37, v68
    v_dot2_f32_bf16 v102, v34, s37, v76
    v_dot2_f32_bf16 v99, v30, s38, v69
    v_dot2_f32_bf16 v103, v34, s38, v77
    v_dot2_f32_bf16 v100, v31, s37, v70
    v_dot2_f32_bf16 v104, v35, s37, v78
    v_dot2_f32_bf16 v101, v31, s38, v71
    v_dot2_f32_bf16 v105, v35, s38, v79
    v_cvt_pk_bf16_f32 v98, 0, v98
    v_cvt_pk_bf16_f32 v99, 0, v99
    v_cvt_pk_bf16_f32 v100, 0, v100
    v_cvt_pk_bf16_f32 v101, 0, v101
    v_cvt_pk_bf16_f32 v102, 0, v102
    v_cvt_pk_bf16_f32 v103, 0, v103
    v_cvt_pk_bf16_f32 v104, 0, v104
    v_cvt_pk_bf16_f32 v105, 0, v105
    v_pk_add_f32 v[98:99], v[98:99], v[46:47]
    v_pk_add_f32 v[102:103], v[102:103], v[60:61]
    v_pk_add_f32 v[100:101], v[100:101], v[48:49]
    v_pk_add_f32 v[104:105], v[104:105], v[62:63]
    v_cvt_pk_bf16_f32 v90, v98, v102
    v_cvt_pk_bf16_f32 v91, v99, v103
    v_cvt_pk_bf16_f32 v92, v100, v104
    v_cvt_pk_bf16_f32 v93, v101, v105
    ds_write2st64_b32 v29, v90, v91 offset0:0 offset1:4
    ds_write2st64_b32 v29, v92, v93 offset0:8 offset1:12
    v_dot2_f32_bf16 v98, v32, s37, v72
    v_dot2_f32_bf16 v102, v36, s37, v86
    v_dot2_f32_bf16 v99, v32, s38, v73
    v_dot2_f32_bf16 v103, v36, s38, v87
    v_dot2_f32_bf16 v100, v33, s37, v74
    v_dot2_f32_bf16 v104, v37, s37, v88
    v_dot2_f32_bf16 v101, v33, s38, v75
    v_dot2_f32_bf16 v105, v37, s38, v89
    v_cvt_pk_bf16_f32 v98, 0, v98
    v_cvt_pk_bf16_f32 v99, 0, v99
    v_cvt_pk_bf16_f32 v100, 0, v100
    v_cvt_pk_bf16_f32 v101, 0, v101
    v_cvt_pk_bf16_f32 v102, 0, v102
    v_cvt_pk_bf16_f32 v103, 0, v103
    v_cvt_pk_bf16_f32 v104, 0, v104
    v_cvt_pk_bf16_f32 v105, 0, v105
    v_pk_add_f32 v[98:99], v[98:99], v[50:51]
    v_pk_add_f32 v[102:103], v[102:103], v[64:65]
    v_pk_add_f32 v[100:101], v[100:101], v[52:53]
    v_pk_add_f32 v[104:105], v[104:105], v[66:67]
    v_cvt_pk_bf16_f32 v94, v98, v102
    v_cvt_pk_bf16_f32 v95, v99, v103
    v_cvt_pk_bf16_f32 v96, v100, v104
    v_cvt_pk_bf16_f32 v97, v101, v105
    ds_write2st64_b32 v29, v94, v95 offset0:16 offset1:20
    ds_write2st64_b32 v29, v96, v97 offset0:24 offset1:28
    s_waitcnt lgkmcnt(0)
    s_barrier
    ds_read_b128 v[30:33], v8 offset:34560
    ds_read_b128 v[34:37], v8 offset:35072
    s_waitcnt lgkmcnt(1)
    v_dot2_f32_bf16 v11, v30, s36, 0
    v_dot2_f32_bf16 v14, v30, v30, 0
    v_dot2_f32_bf16 v15, v30, v20, 0
    v_dot2_f32_bf16 v11, v31, s36, v11
    v_dot2_f32_bf16 v14, v31, v31, v14
    v_dot2_f32_bf16 v15, v31, v21, v15
    v_dot2_f32_bf16 v11, v32, s36, v11
    v_dot2_f32_bf16 v14, v32, v32, v14
    v_dot2_f32_bf16 v15, v32, v22, v15
    v_dot2_f32_bf16 v11, v33, s36, v11
    v_dot2_f32_bf16 v14, v33, v33, v14
    v_dot2_f32_bf16 v15, v33, v23, v15
    s_waitcnt lgkmcnt(0)
    v_dot2_f32_bf16 v11, v34, s36, v11
    v_dot2_f32_bf16 v14, v34, v34, v14
    v_dot2_f32_bf16 v15, v34, v24, v15
    v_dot2_f32_bf16 v11, v35, s36, v11
    v_dot2_f32_bf16 v14, v35, v35, v14
    v_dot2_f32_bf16 v15, v35, v25, v15
    v_dot2_f32_bf16 v11, v36, s36, v11
    v_dot2_f32_bf16 v14, v36, v36, v14
    v_dot2_f32_bf16 v15, v36, v26, v15
    v_dot2_f32_bf16 v11, v37, s36, v11
    v_dot2_f32_bf16 v14, v37, v37, v14
    v_dot2_f32_bf16 v15, v37, v27, v15
    s_nop 0
    v_add_f32_dpp v11, v11, v11 quad_perm:[1,0,3,2] row_mask:0xf bank_mask:0xf
    v_add_f32_dpp v14, v14, v14 quad_perm:[1,0,3,2] row_mask:0xf bank_mask:0xf
    v_add_f32_dpp v15, v15, v15 quad_perm:[1,0,3,2] row_mask:0xf bank_mask:0xf
    v_add_f32_dpp v11, v11, v11 quad_perm:[2,3,0,1] row_mask:0xf bank_mask:0xf
    v_add_f32_dpp v14, v14, v14 quad_perm:[2,3,0,1] row_mask:0xf bank_mask:0xf
    v_add_f32_dpp v15, v15, v15 quad_perm:[2,3,0,1] row_mask:0xf bank_mask:0xf
    v_add_f32_dpp v11, v11, v11 row_half_mirror row_mask:0xf bank_mask:0xf
    v_add_f32_dpp v14, v14, v14 row_half_mirror row_mask:0xf bank_mask:0xf
    v_add_f32_dpp v15, v15, v15 row_half_mirror row_mask:0xf bank_mask:0xf
    v_add_f32_dpp v11, v11, v11 row_mirror row_mask:0xf bank_mask:0xf
    v_add_f32_dpp v14, v14, v14 row_mirror row_mask:0xf bank_mask:0xf
    v_add_f32_dpp v15, v15, v15 row_mirror row_mask:0xf bank_mask:0xf
    v_mov_b32 v42, v11
    v_mov_b32 v43, v14
    v_mov_b32 v44, v15
    v_permlane16_swap_b32 v11, v42
    v_permlane16_swap_b32 v14, v43
    v_permlane16_swap_b32 v15, v44
    v_add_f32 v11, v11, v42
    v_add_f32 v14, v14, v43
    v_add_f32 v15, v15, v44
    v_mul_f32 v11, 0x3b000000, v11
    v_mul_f32 v14, 0x3b000000, v14
    v_fma_f32 v42, -v11, v11, v14
    v_max_f32 v42, 0, v42
    v_cvt_pk_bf16_f32 v42, 0, v42
    v_cvt_pk_bf16_f32 v38, 0, -v11
    v_add_f32 v42, 0x3727c5ac, v42
    v_cvt_pk_bf16_f32 v42, 0, v42
    v_sqrt_f32 v42, v42
    s_nop 0
    v_cvt_pk_bf16_f32 v42, 0, v42
    v_rcp_f32 v40, v42
    v_fma_f32 v15, v38, v13, v15
    v_mul_f32 v15, v15, v40
    v_cvt_pk_bf16_f32 v15, 0, v15
    v_ashrrev_i32 v6, 31, v15
    v_or_b32 v6, 0x80000000, v6
    v_xor_b32 v6, v15, v6
    v_and_b32 v6, 0xffff0000, v6
    v_or_b32 v28, v6, v12
    s_mov_b64 exec, 1
    s_bitset1_b64 exec, 32
    ds_write_b32 v16, v28 offset:42816
    s_mov_b64 exec, -1
    s_waitcnt lgkmcnt(0)
    s_barrier
    ds_read_b128 v[98:101], v10 offset:42816
    ds_read_b128 v[102:105], v10 offset:42832
    v_mov_b32 v39, v38
    v_mov_b32 v41, v40
    v_lshlrev_b32 v20, 16, v30
    v_and_b32 v21, 0xffff0000, v30
    v_lshlrev_b32 v22, 16, v31
    v_and_b32 v23, 0xffff0000, v31
    v_lshlrev_b32 v24, 16, v32
    v_and_b32 v25, 0xffff0000, v32
    v_lshlrev_b32 v26, 16, v33
    v_and_b32 v27, 0xffff0000, v33
    v_lshlrev_b32 v42, 16, v34
    v_and_b32 v43, 0xffff0000, v34
    s_waitcnt lgkmcnt(1)
    v_max3_u32 v11, v98, v99, v100
    s_waitcnt lgkmcnt(0)
    v_max3_u32 v6, v101, v102, v103
    v_max3_u32 v11, v11, v104, v105
    v_max_u32 v11, v11, v6
    s_mov_b64 exec, 3
    global_store_dword v17, v11, s[30:31] sc1
    s_mov_b64 exec, -1
    v_cmp_eq_u32 s[54:55], v28, v11
    v_lshlrev_b32 v44, 16, v35
    v_and_b32 v45, 0xffff0000, v35
    v_lshlrev_b32 v46, 16, v36
    v_and_b32 v47, 0xffff0000, v36
    v_lshlrev_b32 v48, 16, v37
    v_and_b32 v49, 0xffff0000, v37
    v_pk_add_f32 v[58:59], v[20:21], v[38:39]
    v_pk_add_f32 v[60:61], v[22:23], v[38:39]
    v_pk_add_f32 v[62:63], v[24:25], v[38:39]
    v_pk_add_f32 v[64:65], v[26:27], v[38:39]
    v_pk_add_f32 v[66:67], v[42:43], v[38:39]
    v_pk_add_f32 v[68:69], v[44:45], v[38:39]
    v_pk_add_f32 v[70:71], v[46:47], v[38:39]
    v_pk_add_f32 v[72:73], v[48:49], v[38:39]
    v_cvt_pk_bf16_f32 v58, 0, v58
    v_cvt_pk_bf16_f32 v59, 0, v59
    v_cvt_pk_bf16_f32 v60, 0, v60
    v_cvt_pk_bf16_f32 v61, 0, v61
    v_cvt_pk_bf16_f32 v62, 0, v62
    v_cvt_pk_bf16_f32 v63, 0, v63
    v_cvt_pk_bf16_f32 v64, 0, v64
    v_cvt_pk_bf16_f32 v65, 0, v65
    v_cvt_pk_bf16_f32 v66, 0, v66
    v_cvt_pk_bf16_f32 v67, 0, v67
    v_cvt_pk_bf16_f32 v68, 0, v68
    v_cvt_pk_bf16_f32 v69, 0, v69
    v_cvt_pk_bf16_f32 v70, 0, v70
    v_cvt_pk_bf16_f32 v71, 0, v71
    v_cvt_pk_bf16_f32 v72, 0, v72
    v_cvt_pk_bf16_f32 v73, 0, v73
    v_pk_mul_f32 v[58:59], v[58:59], v[40:41]
    v_pk_mul_f32 v[60:61], v[60:61], v[40:41]
    v_pk_mul_f32 v[62:63], v[62:63], v[40:41]
    v_pk_mul_f32 v[64:65], v[64:65], v[40:41]
    v_pk_mul_f32 v[66:67], v[66:67], v[40:41]
    v_pk_mul_f32 v[68:69], v[68:69], v[40:41]
    v_pk_mul_f32 v[70:71], v[70:71], v[40:41]
    v_pk_mul_f32 v[72:73], v[72:73], v[40:41]
    v_cvt_pk_bf16_f32 v50, v58, v59
    v_cvt_pk_bf16_f32 v51, v60, v61
    v_cvt_pk_bf16_f32 v52, v62, v63
    v_cvt_pk_bf16_f32 v53, v64, v65
    v_cvt_pk_bf16_f32 v54, v66, v67
    v_cvt_pk_bf16_f32 v55, v68, v69
    v_cvt_pk_bf16_f32 v56, v70, v71
    v_cvt_pk_bf16_f32 v57, v72, v73
    s_mov_b64 exec, s[54:55]
    global_store_dwordx4 v18, v[50:53], s[30:31] sc1
    global_store_dwordx4 v18, v[54:57], s[30:31] offset:512 sc1
    global_store_dwordx4 v18, v[30:33], s[30:31] offset:1024 sc1
    global_store_dwordx4 v18, v[34:37], s[30:31] offset:1536 sc1
    s_mov_b64 exec, -1
    s_barrier
    v_dot2_f32_bf16 v58, v50, s37, v20
    v_dot2_f32_bf16 v59, v50, s38, v21
    v_dot2_f32_bf16 v60, v51, s37, v22
    v_dot2_f32_bf16 v61, v51, s38, v23
    v_dot2_f32_bf16 v62, v52, s37, v24
    v_dot2_f32_bf16 v63, v52, s38, v25
    v_dot2_f32_bf16 v64, v53, s37, v26
    v_dot2_f32_bf16 v65, v53, s38, v27
    v_dot2_f32_bf16 v66, v54, s37, v42
    v_dot2_f32_bf16 v67, v54, s38, v43
    v_dot2_f32_bf16 v68, v55, s37, v44
    v_dot2_f32_bf16 v69, v55, s38, v45
    v_dot2_f32_bf16 v70, v56, s37, v46
    v_dot2_f32_bf16 v71, v56, s38, v47
    v_dot2_f32_bf16 v72, v57, s37, v48
    v_dot2_f32_bf16 v73, v57, s38, v49
    v_cvt_pk_bf16_f32 v90, v58, v59
    v_cvt_pk_bf16_f32 v91, v60, v61
    v_cvt_pk_bf16_f32 v92, v62, v63
    v_cvt_pk_bf16_f32 v93, v64, v65
    v_cvt_pk_bf16_f32 v94, v66, v67
    v_cvt_pk_bf16_f32 v95, v68, v69
    v_cvt_pk_bf16_f32 v96, v70, v71
    v_cvt_pk_bf16_f32 v97, v72, v73
    s_cmp_eq_u32 s50, 1
    s_cbranch_scc1 L_role1
    s_cmp_eq_u32 s50, 2
    s_cbranch_scc1 L_role2
    s_mul_i32 s52, s33, 8192
    s_add_u32 s52, s52, 60416
    v_lshrrev_b32 v12, 2, v2
    v_lshl_add_u32 v12, v3, 3, v12
    v_and_b32 v6, 2, v2
    v_lshl_add_u32 v12, v6, 7, v12
    v_and_b32 v15, 1, v3
    v_or_b32 v6, v6, v15
    v_xor_b32 v6, s33, v6
    v_lshlrev_b32 v6, 4, v6
    v_lshl_add_u32 v12, v12, 6, v6
    v_and_b32 v6, 1, v2
    v_lshl_add_u32 v12, v6, 3, v12
    v_add_u32 v14, 60416, v12
    v_lshlrev_b32 v6, 6, v2
    v_lshl_add_u32 v16, v3, 4, v6
    v_lshrrev_b32 v12, 3, v1
    s_lshl_b32 s3, s33, 4
    s_lshl_b32 s16, s51, 12
    s_add_u32 s3, s3, s16
    s_lshl_b32 s16, s49, 6
    s_add_u32 s3, s3, s16
    s_add_u32 s3, s3, 65536
    v_lshl_add_u32 v17, v12, 13, s3
    v_mov_b32 v15, 0
    v_mov_b32 v18, 0
    s_waitcnt vmcnt(4)
    s_lshl_b32 s3, s33, 10
    v_subrev_u32 v10, s3, v19
    global_load_dword v98, v10, s[30:31] offset:0 sc1
    global_load_dword v99, v10, s[30:31] offset:1024 sc1
    global_load_dword v100, v10, s[30:31] offset:2048 sc1
    global_load_dword v101, v10, s[30:31] offset:3072 sc1
    s_waitcnt vmcnt(1)
    v_max3_u32 v13, v98, v99, v100
    s_waitcnt vmcnt(0)
    v_max_u32 v13, v13, v101
    v_cmp_eq_u32 vcc, -1, v13
    s_cbranch_vccnz L_s3r0_slow
L_s3r0_ok:
    v_max_u32_dpp v13, v13, v13 quad_perm:[1,0,3,2] row_mask:0xf bank_mask:0xf
    s_nop 1
    v_max_u32_dpp v13, v13, v13 quad_perm:[2,3,0,1] row_mask:0xf bank_mask:0xf
    s_nop 1
    v_max_u32_dpp v13, v13, v13 row_half_mirror row_mask:0xf bank_mask:0xf
    s_nop 1
    v_max_u32_dpp v13, v13, v13 row_mirror row_mask:0xf bank_mask:0xf
    v_mov_b32 v20, v13
    s_nop 1
    v_permlane16_swap_b32 v13, v20
    v_max_u32 v13, v13, v20
    v_mov_b32 v20, v13
    s_nop 1
    v_permlane32_swap_b32 v13, v20
    v_max_u32 v13, v13, v20
    s_nop 0
    v_readfirstlane_b32 s53, v13
    s_nop 0
    s_and_b32 s56, s53, 0x7ff
    s_sub_u32 s56, 2047, s56
    s_lshr_b32 s3, s56, 3
    s_lshl_b32 s3, s3, 11
    s_add_u32 s3, s3, 131072
    v_add_u32 v16, s3, v16
    global_load_dwordx4 v[20:23], v16, s[30:31] sc1
    v_cmp_ne_u32 s[54:55], v13, v28
    s_barrier
    ds_read_b64_tr_b16 a[0:1], v14 offset:0
    ds_read_b64_tr_b16 a[2:3], v14 offset:256
    ds_read_b64_tr_b16 a[4:5], v14 offset:2048
    ds_read_b64_tr_b16 a[6:7], v14 offset:2304
    ds_read_b64_tr_b16 a[8:9], v14 offset:4096
    ds_read_b64_tr_b16 a[10:11], v14 offset:4352
    ds_read_b64_tr_b16 a[12:13], v14 offset:6144
    ds_read_b64_tr_b16 a[14:15], v14 offset:6400
    ds_read_b64_tr_b16 a[16:17], v14 offset:8192
    ds_read_b64_tr_b16 a[18:19], v14 offset:8448
    ds_read_b64_tr_b16 a[20:21], v14 offset:10240
    ds_read_b64_tr_b16 a[22:23], v14 offset:10496
    ds_read_b64_tr_b16 a[24:25], v14 offset:12288
    ds_read_b64_tr_b16 a[26:27], v14 offset:12544
    ds_read_b64_tr_b16 a[28:29], v14 offset:14336
    ds_read_b64_tr_b16 a[30:31], v14 offset:14592
    s_waitcnt vmcnt(0)
    v_max3_u32 v6, v20, v21, v22
    v_max3_u32 v6, v6, v23, v23
    v_cmp_eq_u32 vcc, -1, v6
    s_cbranch_vccnz L_rowr0_slow
L_rowr0_ok:
    s_waitcnt lgkmcnt(14)
    v_mfma_f32_16x16x32_bf16 v[58:61], v[20:23], a[0:3], 0
    s_cmp_eq_u32 s51, 0
    s_cselect_b64 s[16:17], -1, 0
    s_waitcnt lgkmcnt(12)
    v_mfma_f32_16x16x32_bf16 v[62:65], v[20:23], a[4:7], 0
    s_waitcnt lgkmcnt(10)
    v_mfma_f32_16x16x32_bf16 v[66:69], v[20:23], a[8:11], 0
    s_waitcnt lgkmcnt(8)
    v_mfma_f32_16x16x32_bf16 v[70:73], v[20:23], a[12:15], 0
    s_waitcnt lgkmcnt(6)
    v_mfma_f32_16x16x32_bf16 v[74:77], v[20:23], a[16:19], 0
    v_add_f32_dpp v15, v58, v15 quad_perm:[0,1,2,3] row_mask:5 bank_mask:0xf
    s_waitcnt lgkmcnt(4)
    v_mfma_f32_16x16x32_bf16 v[78:81], v[20:23], a[20:23], 0
    v_add_f32_dpp v18, v63, v18 quad_perm:[0,1,2,3] row_mask:5 bank_mask:0xf
    s_waitcnt lgkmcnt(2)
    v_mfma_f32_16x16x32_bf16 v[82:85], v[20:23], a[24:27], 0
    v_add_f32_dpp v15, v68, v15 quad_perm:[0,1,2,3] row_mask:5 bank_mask:0xf
    s_waitcnt lgkmcnt(0)
    v_mfma_f32_16x16x32_bf16 v[86:89], v[20:23], a[28:31], 0
    v_add_f32_dpp v18, v73, v18 quad_perm:[0,1,2,3] row_mask:5 bank_mask:0xf
    v_add_f32_dpp v15, v74, v15 quad_perm:[0,1,2,3] row_mask:10 bank_mask:0xf
    s_nop 0
    v_add_f32_dpp v18, v79, v18 quad_perm:[0,1,2,3] row_mask:10 bank_mask:0xf
    s_nop 0
    v_add_f32_dpp v15, v84, v15 quad_perm:[0,1,2,3] row_mask:10 bank_mask:0xf
    s_nop 1
    v_add_f32_dpp v18, v89, v18 quad_perm:[0,1,2,3] row_mask:10 bank_mask:0xf
    v_add_f32 v6, v15, v18
    v_add_f32 v98, v15, v18
    s_nop 1
    v_mov_b32_dpp v98, v6 row_ror:8 row_mask:0x3 bank_mask:0xc
    s_nop 1
    v_mov_b32_dpp v98, v6 row_ror:8 row_mask:0xc bank_mask:0x3
    v_mov_b32 v6, v98
    s_nop 1
    v_permlane16_swap_b32 v98, v6
    v_add_f32 v98, v98, v6
    v_mov_b32 v6, v98
    s_nop 1
    v_permlane32_swap_b32 v98, v6
    v_add_f32 v98, v98, v6
    v_cvt_pk_bf16_f32 v98, 0, v98
    v_mul_f32 v6, 3216550459, v98
    v_exp_f32 v6, v6
    s_nop 0
    v_add_f32 v6, 1.0, v6
    v_rcp_f32 v6, v6
    s_nop 0
    v_mul_f32 v6, v98, v6
    v_cndmask_b32 v6, v98, v6, s[16:17]
    s_nop 1
    v_mov_b32_dpp v10, v6 row_shl:1 row_mask:0xf bank_mask:0xf
    v_cvt_pk_bf16_f32 v20, v6, v10
    s_nop 1
    v_mov_b32_dpp v21, v20 row_shl:2 row_mask:0xf bank_mask:0xf
    v_mov_b32_dpp v22, v20 row_shl:4 row_mask:0xf bank_mask:0xf
    v_mov_b32_dpp v23, v20 row_shl:6 row_mask:0xf bank_mask:0xf
    s_mov_b32 exec_lo, 0x01010101
    s_mov_b32 exec_hi, 0x01010101
    global_store_dwordx4 v17, v[20:23], s[30:31] sc1
    s_waitcnt vmcnt(0)
    s_mov_b64 exec, s[54:55]
    global_store_dwordx4 v9, v[90:93], s[28:29] sc1
    global_store_dwordx4 v9, v[94:97], s[28:29] offset:512 sc1
    s_nop 1
L_fin_r0:
    s_endpgm
L_role2:
    s_waitcnt vmcnt(4)
    s_andn2_b64 exec, -1, s[54:55]
    global_store_dwordx4 v9, v[90:93], s[28:29] sc1
    global_store_dwordx4 v9, v[94:97], s[28:29] offset:512 sc1
    s_mov_b64 exec, -1
    s_waitcnt vmcnt(0)
    global_load_dword v13, v19, s[30:31] sc1
    v_lshrrev_b32 v10, 4, v0
    v_and_b32 v10, 12, v10
    v_mov_b32 v12, 0
    s_waitcnt vmcnt(0)
    v_cmp_eq_u32 vcc, -1, v13
    s_cbranch_vccnz L_s3r2_slow
L_s3r2_ok:
    v_max_u32_dpp v13, v13, v13 quad_perm:[1,0,3,2] row_mask:0xf bank_mask:0xf
    s_nop 1
    v_max_u32_dpp v13, v13, v13 quad_perm:[2,3,0,1] row_mask:0xf bank_mask:0xf
    s_nop 1
    v_max_u32_dpp v13, v13, v13 row_half_mirror row_mask:0xf bank_mask:0xf
    s_nop 1
    v_max_u32_dpp v13, v13, v13 row_mirror row_mask:0xf bank_mask:0xf
    v_mov_b32 v14, v13
    s_nop 1
    v_permlane16_swap_b32 v13, v14
    v_max_u32 v13, v13, v14
    v_mov_b32 v14, v13
    s_nop 1
    v_permlane32_swap_b32 v13, v14
    v_max_u32 v13, v13, v14
    s_mov_b64 exec, 1
    ds_write_b32 v10, v13 offset:42848
    s_mov_b64 exec, -1
    s_waitcnt lgkmcnt(0)
    s_barrier
    ds_read_b128 v[98:101], v12 offset:42848
    s_waitcnt lgkmcnt(0)
    v_max3_u32 v13, v98, v99, v100
    v_max_u32 v13, v13, v101
    s_nop 0
    v_readfirstlane_b32 s53, v13
    s_nop 0
    s_and_b32 s56, s53, 0x7ff
    s_sub_u32 s56, 2047, s56
    s_lshr_b32 s3, s56, 3
    s_lshl_b32 s3, s3, 11
    s_add_u32 s3, s3, 131072
    v_cmp_ne_u32 vcc, v13, v11
    s_nop 0
    s_and_b64 exec, vcc, s[54:55]
    global_store_dwordx4 v9, v[90:93], s[28:29] sc1
    global_store_dwordx4 v9, v[94:97], s[28:29] offset:512 sc1
    s_nop 1
L_fin_r2:
    s_endpgm
.p2alignl 12, 0xbf810000
L_role1:
    s_mul_i32 s52, s33, 14336
    s_add_u32 s52, s52, 60416
    s_waitcnt vmcnt(4)
    s_lshl_b32 s3, s33, 10
    v_subrev_u32 v10, s3, v19
    global_load_dword v98, v10, s[30:31] offset:0 sc1
    global_load_dword v99, v10, s[30:31] offset:1024 sc1
    global_load_dword v100, v10, s[30:31] offset:2048 sc1
    global_load_dword v101, v10, s[30:31] offset:3072 sc1
    s_waitcnt vmcnt(1)
    v_max3_u32 v13, v98, v99, v100
    s_waitcnt vmcnt(0)
    v_max_u32 v13, v13, v101
    v_cmp_eq_u32 vcc, -1, v13
    s_cbranch_vccnz L_s3r1_slow
L_s3r1_ok:
    v_max_u32_dpp v13, v13, v13 quad_perm:[1,0,3,2] row_mask:0xf bank_mask:0xf
    s_nop 1
    v_max_u32_dpp v13, v13, v13 quad_perm:[2,3,0,1] row_mask:0xf bank_mask:0xf
    s_nop 1
    v_max_u32_dpp v13, v13, v13 row_half_mirror row_mask:0xf bank_mask:0xf
    s_nop 1
    v_max_u32_dpp v13, v13, v13 row_mirror row_mask:0xf bank_mask:0xf
    v_mov_b32 v14, v13
    s_nop 1
    v_permlane16_swap_b32 v13, v14
    v_max_u32 v13, v13, v14
    v_mov_b32 v14, v13
    s_nop 1
    v_permlane32_swap_b32 v13, v14
    v_max_u32 v13, v13, v14
    s_nop 0
    v_readfirstlane_b32 s53, v13
    s_nop 0
    s_and_b32 s56, s53, 0x7ff
    s_sub_u32 s56, 2047, s56
    s_lshr_b32 s3, s56, 3
    s_lshl_b32 s3, s3, 11
    s_add_u32 s3, s3, 131072
    s_lshl_b32 s16, s49, 5
    s_add_u32 s3, s3, s16
    v_lshrrev_b32 v10, 1, v2
    v_lshl_add_u32 v10, v10, 2, s3
    global_load_dword v20, v10, s[30:31] sc1
    global_load_dword v21, v10, s[30:31] offset:1024 sc1
    s_barrier
    v_cmp_eq_u32 vcc, v13, v28
    s_nop 0
    s_andn2_b64 exec, -1, vcc
    global_store_dwordx4 v9, v[90:93], s[28:29] sc1
    global_store_dwordx4 v9, v[94:97], s[28:29] offset:512 sc1
    s_mov_b64 exec, -1
    v_and_b32 v6, 3, v2
    v_lshlrev_b32 v6, 3, v6
    v_lshrrev_b32 v12, 2, v2
    v_lshl_add_u32 v12, v3, 3, v12
    v_lshl_add_u32 v6, v12, 5, v6
    v_add_u32 v14, s52, v6
    s_waitcnt vmcnt(2)
    v_max3_u32 v6, v20, v21, v21
    v_cmp_eq_u32 vcc, -1, v6
    s_cbranch_vccnz L_rowr1_slow
L_rowr1_ok:
    s_barrier
    ds_read_b64_tr_b16 a[0:1], v14 offset:0
    ds_read_b64_tr_b16 a[2:3], v14 offset:128
    ds_read_b64_tr_b16 a[4:5], v14 offset:1024
    ds_read_b64_tr_b16 a[6:7], v14 offset:1152
    ds_read_b64_tr_b16 a[8:9], v14 offset:2048
    ds_read_b64_tr_b16 a[10:11], v14 offset:2176
    ds_read_b64_tr_b16 a[12:13], v14 offset:3072
    ds_read_b64_tr_b16 a[14:15], v14 offset:3200
    ds_read_b64_tr_b16 a[16:17], v14 offset:4096
    ds_read_b64_tr_b16 a[18:19], v14 offset:4224
    ds_read_b64_tr_b16 a[20:21], v14 offset:5120
    ds_read_b64_tr_b16 a[22:23], v14 offset:5248
    ds_read_b64_tr_b16 a[24:25], v14 offset:6144
    ds_read_b64_tr_b16 a[26:27], v14 offset:6272
    ds_read_b64_tr_b16 a[28:29], v14 offset:7168
    ds_read_b64_tr_b16 a[30:31], v14 offset:7296
    ds_read_b64_tr_b16 a[32:33], v14 offset:8192
    ds_read_b64_tr_b16 a[34:35], v14 offset:8320
    ds_read_b64_tr_b16 a[36:37], v14 offset:9216
    ds_read_b64_tr_b16 a[38:39], v14 offset:9344
    ds_read_b64_tr_b16 a[40:41], v14 offset:10240
    ds_read_b64_tr_b16 a[42:43], v14 offset:10368
    ds_read_b64_tr_b16 a[44:45], v14 offset:11264
    ds_read_b64_tr_b16 a[46:47], v14 offset:11392
    ds_read_b64_tr_b16 a[48:49], v14 offset:12288
    ds_read_b64_tr_b16 a[50:51], v14 offset:12416
    ds_read_b64_tr_b16 a[52:53], v14 offset:13312
    ds_read_b64_tr_b16 a[54:55], v14 offset:13440
    s_and_b32 s16, s53, 0x7fff0000
    s_andn2_b32 s17, 0xffff0000, s53
    s_bitcmp1_b32 s53, 31
    s_cselect_b32 s16, s16, s17
    v_mov_b32 v6, s16
    v_mul_f32 v6, 3216550459, v6
    v_exp_f32 v6, v6
    s_nop 0
    v_add_f32 v6, 1.0, v6
    v_rcp_f32 v6, v6
    s_nop 0
    v_cvt_pk_bf16_f32 v16, 0, v6
    v_and_b32 v6, 1, v2
    v_xor_b32 v6, 1, v6
    v_lshlrev_b32 v6, 4, v6
    v_lshlrev_b32 v20, v6, v20
    v_lshlrev_b32 v21, v6, v21
    v_and_b32 v20, 0xffff0000, v20
    v_and_b32 v21, 0xffff0000, v21
    s_lshl_b32 s3, s56, 10
    s_lshl_b32 s16, s49, 5
    s_add_u32 s3, s3, s16
    v_lshl_add_u32 v17, v2, 1, s3
    s_lshl_b32 s3, s33, 2
    v_lshl_add_u32 v15, v2, 4, s3
    v_mov_b32 v12, 0
    v_lshlrev_b32 v10, 4, v2
    s_lshr_b32 s3, s32, 5
    s_lshl_b32 s3, s3, 13
    s_mul_i32 s16, s33, 896
    s_add_u32 s3, s3, s16
    s_add_u32 s3, s3, 65536
    v_min_u32 v6, 13, v2
    v_lshl_add_u32 v6, v6, 2, v3
    v_lshl_add_u32 v18, v6, 4, s3
    v_add_u32 v22, 0x1000, v18
    s_waitcnt vmcnt(0)
    global_load_dwordx4 v[24:27], v18, s[30:31] sc1
    global_load_dwordx4 v[38:41], v22, s[30:31] sc1
    s_waitcnt vmcnt(1)
    v_max3_u32 v6, v24, v25, v26
    s_waitcnt vmcnt(0)
    v_max3_u32 v6, v6, v27, v38
    v_max3_u32 v6, v6, v39, v40
    v_max3_u32 v6, v6, v41, v41
    v_cmp_eq_u32 vcc, -1, v6
    s_cbranch_vccnz L_s4_slow
L_s4_ok:
    v_and_b32 v98, 0xffff, v24
    v_and_b32 v99, 0xffff0000, v24
    v_and_b32 v100, 0xffff, v25
    v_and_b32 v101, 0xffff0000, v25
    v_and_b32 v102, 0xffff, v26
    v_and_b32 v103, 0xffff0000, v26
    v_and_b32 v104, 0xffff, v27
    v_and_b32 v105, 0xffff0000, v27
    v_dot2_f32_bf16 v98, v98, v38, 0
    v_dot2_f32_bf16 v99, v99, v38, 0
    v_dot2_f32_bf16 v100, v100, v39, 0
    v_dot2_f32_bf16 v101, v101, v39, 0
    v_dot2_f32_bf16 v102, v102, v40, 0
    v_dot2_f32_bf16 v103, v103, v40, 0
    v_dot2_f32_bf16 v104, v104, v41, 0
    v_dot2_f32_bf16 v105, v105, v41, 0
    v_cvt_pk_bf16_f32 v42, v98, v99
    v_cvt_pk_bf16_f32 v43, v100, v101
    v_cvt_pk_bf16_f32 v44, v102, v103
    v_cvt_pk_bf16_f32 v45, v104, v105
    v_mov_b32 v23, 0
    s_waitcnt lgkmcnt(15)
    v_mfma_f32_16x16x32_bf16 v[58:61], v[42:45], a[0:3], 0
    v_mfma_f32_16x16x32_bf16 v[62:65], v[42:45], a[4:7], 0
    v_mfma_f32_16x16x32_bf16 v[66:69], v[42:45], a[8:11], 0
    v_mfma_f32_16x16x32_bf16 v[70:73], v[42:45], a[12:15], 0
    v_mfma_f32_16x16x32_bf16 v[74:77], v[42:45], a[16:19], 0
    s_nop 3
    v_add_f32_dpp v12, v58, v12 quad_perm:[0,1,2,3] row_mask:1 bank_mask:0xf
    v_mfma_f32_16x16x32_bf16 v[78:81], v[42:45], a[20:23], 0
    v_add_f32_dpp v23, v63, v23 quad_perm:[0,1,2,3] row_mask:1 bank_mask:0xf
    s_waitcnt lgkmcnt(14)
    v_mfma_f32_16x16x32_bf16 v[82:85], v[42:45], a[24:27], 0
    v_add_f32_dpp v12, v68, v12 quad_perm:[0,1,2,3] row_mask:1 bank_mask:0xf
    s_waitcnt lgkmcnt(12)
    v_mfma_f32_16x16x32_bf16 v[86:89], v[42:45], a[28:31], 0
    v_add_f32_dpp v23, v73, v23 quad_perm:[0,1,2,3] row_mask:1 bank_mask:0xf
    s_waitcnt lgkmcnt(10)
    v_mfma_f32_16x16x32_bf16 v[58:61], v[42:45], a[32:35], 0
    v_add_f32_dpp v12, v74, v12 quad_perm:[0,1,2,3] row_mask:2 bank_mask:0xf
    s_waitcnt lgkmcnt(8)
    v_mfma_f32_16x16x32_bf16 v[62:65], v[42:45], a[36:39], 0
    v_add_f32_dpp v23, v79, v23 quad_perm:[0,1,2,3] row_mask:2 bank_mask:0xf
    s_waitcnt lgkmcnt(6)
    v_mfma_f32_16x16x32_bf16 v[66:69], v[42:45], a[40:43], 0
    v_add_f32_dpp v12, v84, v12 quad_perm:[0,1,2,3] row_mask:2 bank_mask:0xf
    s_waitcnt lgkmcnt(4)
    v_mfma_f32_16x16x32_bf16 v[70:73], v[42:45], a[44:47], 0
    v_add_f32_dpp v23, v89, v23 quad_perm:[0,1,2,3] row_mask:2 bank_mask:0xf
    s_waitcnt lgkmcnt(2)
    v_mfma_f32_16x16x32_bf16 v[74:77], v[42:45], a[48:51], 0
    v_add_f32_dpp v12, v58, v12 quad_perm:[0,1,2,3] row_mask:4 bank_mask:0xf
    s_waitcnt lgkmcnt(0)
    v_mfma_f32_16x16x32_bf16 v[78:81], v[42:45], a[52:55], 0
    v_add_f32_dpp v23, v63, v23 quad_perm:[0,1,2,3] row_mask:4 bank_mask:0xf
    v_add_f32_dpp v12, v68, v12 quad_perm:[0,1,2,3] row_mask:4 bank_mask:0xf
    s_nop 0
    v_add_f32_dpp v23, v73, v23 quad_perm:[0,1,2,3] row_mask:4 bank_mask:0xf
    s_nop 0
    v_add_f32_dpp v12, v74, v12 quad_perm:[0,1,2,3] row_mask:8 bank_mask:0xf
    s_nop 1
    v_add_f32_dpp v23, v79, v23 quad_perm:[0,1,2,3] row_mask:8 bank_mask:0xf
    v_add_f32 v12, v12, v23
    v_mov_b32 v6, v12
    s_nop 1
    v_permlane16_swap_b32 v12, v6
    v_add_f32 v12, v12, v6
    v_mov_b32 v6, v12
    s_nop 1
    v_permlane32_swap_b32 v12, v6
    v_add_f32 v12, v12, v6
    s_mov_b64 exec, 0xffff
    ds_write_b32 v15, v12 offset:42880
    s_mov_b64 exec, -1
    s_waitcnt lgkmcnt(0)
    s_barrier
    s_cmp_eq_u32 s33, 0
    s_cbranch_scc0 L_fin_r1
    ds_read_b128 v[98:101], v10 offset:42880
    s_waitcnt lgkmcnt(0)
    v_pk_add_f32 v[98:99], v[98:99], v[100:101]
    v_add_f32 v6, v98, v99
    v_cvt_pk_bf16_f32 v6, 0, v6
    v_mul_f32 v6, v6, v16
    v_cvt_pk_bf16_f32 v6, 0, v6
    v_add_f32 v6, v6, v20
    v_cvt_pk_bf16_f32 v6, 0, v6
    v_add_f32 v6, v6, v21
    v_cvt_pk_bf16_f32 v6, 0, v6
    s_mov_b64 exec, 0xffff
    global_store_short_d16_hi v17, v6, s[28:29]
    s_cmp_eq_u32 s49, 0
    s_cbranch_scc0 L_fin_r1
    s_mov_b64 exec, 1
    v_mov_b32 v6, s35
    v_mov_b32 v12, 0
    global_store_dword v12, v6, s[30:31] offset:0
    s_nop 1
L_fin_r1:
    s_endpgm
L_s1_slow:
    s_mov_b32 s3, 0
L_s1_loop:
    s_mov_b64 exec, vcc
    s_nop 1
    global_load_dwordx4 v[66:69], v64, s[30:31] sc1
    global_load_dwordx4 v[70:73], v65, s[30:31] sc1
    s_add_u32 s3, s3, 1
    s_cmp_ge_u32 s3, 1048576
    s_cselect_b32 s18, 0, -1
    s_mov_b32 s19, s18
    s_waitcnt vmcnt(1)
    v_xor_b32 v66, s34, v66
    v_xor_b32 v67, s46, v67
    v_xor_b32 v68, s47, v68
    v_xor_b32 v69, s48, v69
    s_waitcnt vmcnt(0)
    v_xor_b32 v70, s34, v70
    v_xor_b32 v71, s46, v71
    v_xor_b32 v72, s47, v72
    v_xor_b32 v73, s48, v73
    v_or3_b32 v10, v66, v67, v68
    v_or3_b32 v17, v69, v70, v71
    v_or3_b32 v10, v10, v72, v73
    v_or_b32 v10, v10, v17
    v_and_b32 v10, 1074216967, v10
    v_cmp_ne_u32 vcc, 0, v10
    s_nop 1
    s_and_b64 vcc, vcc, s[18:19]
    s_cbranch_vccnz L_s1_loop
    s_mov_b64 exec, -1
    s_nop 2
    s_branch L_s1_ok
L_s2_slow:
    s_mov_b32 s3, 0
L_s2_loop:
    s_mov_b64 exec, vcc
    s_nop 1
    global_load_dwordx4 v[30:33], v14, s[30:31] sc1
    global_load_dwordx4 v[34:37], v15, s[30:31] sc1
    s_add_u32 s3, s3, 1
    s_cmp_ge_u32 s3, 1048576
    s_cselect_b32 s18, 0, -1
    s_mov_b32 s19, s18
    s_waitcnt vmcnt(1)
    v_max3_u32 v6, v30, v31, v32
    s_waitcnt vmcnt(0)
    v_max3_u32 v6, v6, v33, v34
    v_max3_u32 v6, v6, v35, v36
    v_max3_u32 v6, v6, v37, v37
    v_cmp_eq_u32 vcc, -1, v6
    s_nop 1
    s_and_b64 vcc, vcc, s[18:19]
    s_cbranch_vccnz L_s2_loop
    s_mov_b64 exec, -1
    s_nop 2
    s_branch L_s2_ok
L_s3r0_slow:
    s_mov_b32 s3, 0
L_s3r0_loop:
    s_mov_b64 exec, vcc
    s_nop 1
    global_load_dword v98, v10, s[30:31] offset:0 sc1
    global_load_dword v99, v10, s[30:31] offset:1024 sc1
    global_load_dword v100, v10, s[30:31] offset:2048 sc1
    global_load_dword v101, v10, s[30:31] offset:3072 sc1
    s_add_u32 s3, s3, 1
    s_cmp_ge_u32 s3, 1048576
    s_cselect_b32 s18, 0, -1
    s_mov_b32 s19, s18
    s_waitcnt vmcnt(1)
    v_max3_u32 v13, v98, v99, v100
    s_waitcnt vmcnt(0)
    v_max_u32 v13, v13, v101
    v_cmp_eq_u32 vcc, -1, v13
    s_nop 1
    s_and_b64 vcc, vcc, s[18:19]
    s_cbranch_vccnz L_s3r0_loop
    s_mov_b64 exec, -1
    s_nop 2
    s_branch L_s3r0_ok
L_rowr0_slow:
    s_mov_b32 s3, 0
L_rowr0_loop:
    s_mov_b64 exec, vcc
    s_nop 1
    global_load_dwordx4 v[20:23], v16, s[30:31] sc1
    s_add_u32 s3, s3, 1
    s_cmp_ge_u32 s3, 1048576
    s_cselect_b32 s18, 0, -1
    s_mov_b32 s19, s18
    s_waitcnt vmcnt(0)
    v_max3_u32 v6, v20, v21, v22
    v_max3_u32 v6, v6, v23, v23
    v_cmp_eq_u32 vcc, -1, v6
    s_nop 1
    s_and_b64 vcc, vcc, s[18:19]
    s_cbranch_vccnz L_rowr0_loop
    s_mov_b64 exec, -1
    s_nop 2
    s_branch L_rowr0_ok
L_s3r1_slow:
    s_mov_b32 s3, 0
L_s3r1_loop:
    s_mov_b64 exec, vcc
    s_nop 1
    global_load_dword v98, v10, s[30:31] offset:0 sc1
    global_load_dword v99, v10, s[30:31] offset:1024 sc1
    global_load_dword v100, v10, s[30:31] offset:2048 sc1
    global_load_dword v101, v10, s[30:31] offset:3072 sc1
    s_add_u32 s3, s3, 1
    s_cmp_ge_u32 s3, 1048576
    s_cselect_b32 s18, 0, -1
    s_mov_b32 s19, s18
    s_waitcnt vmcnt(1)
    v_max3_u32 v13, v98, v99, v100
    s_waitcnt vmcnt(0)
    v_max_u32 v13, v13, v101
    v_cmp_eq_u32 vcc, -1, v13
    s_nop 1
    s_and_b64 vcc, vcc, s[18:19]
    s_cbranch_vccnz L_s3r1_loop
    s_mov_b64 exec, -1
    s_nop 2
    s_branch L_s3r1_ok
L_rowr1_slow:
    s_mov_b32 s3, 0
L_rowr1_loop:
    s_mov_b64 exec, vcc
    s_nop 1
    global_load_dword v20, v10, s[30:31] sc1
    global_load_dword v21, v10, s[30:31] offset:1024 sc1
    s_add_u32 s3, s3, 1
    s_cmp_ge_u32 s3, 1048576
    s_cselect_b32 s18, 0, -1
    s_mov_b32 s19, s18
    s_waitcnt vmcnt(0)
    v_max3_u32 v6, v20, v21, v21
    v_cmp_eq_u32 vcc, -1, v6
    s_nop 1
    s_and_b64 vcc, vcc, s[18:19]
    s_cbranch_vccnz L_rowr1_loop
    s_mov_b64 exec, -1
    s_nop 2
    s_branch L_rowr1_ok
L_s4_slow:
    s_mov_b32 s3, 0
L_s4_loop:
    s_mov_b64 exec, vcc
    s_nop 1
    global_load_dwordx4 v[24:27], v18, s[30:31] sc1
    global_load_dwordx4 v[38:41], v22, s[30:31] sc1
    s_add_u32 s3, s3, 1
    s_cmp_ge_u32 s3, 1048576
    s_cselect_b32 s18, 0, -1
    s_mov_b32 s19, s18
    s_waitcnt vmcnt(1)
    v_max3_u32 v6, v24, v25, v26
    s_waitcnt vmcnt(0)
    v_max3_u32 v6, v6, v27, v38
    v_max3_u32 v6, v6, v39, v40
    v_max3_u32 v6, v6, v41, v41
    v_cmp_eq_u32 vcc, -1, v6
    s_nop 1
    s_and_b64 vcc, vcc, s[18:19]
    s_cbranch_vccnz L_s4_loop
    s_mov_b64 exec, -1
    s_nop 2
    s_branch L_s4_ok
L_s3r2_slow:
    s_mov_b32 s3, 0
L_s3r2_loop:
    s_mov_b64 exec, vcc
    s_nop 1
    global_load_dword v13, v19, s[30:31] sc1
    s_add_u32 s3, s3, 1
    s_cmp_ge_u32 s3, 1048576
    s_cselect_b32 s18, 0, -1
    s_mov_b32 s19, s18
    s_waitcnt vmcnt(0)
    v_cmp_eq_u32 vcc, -1, v13
    s_nop 1
    s_and_b64 vcc, vcc, s[18:19]
    s_cbranch_vccnz L_s3r2_loop
    s_mov_b64 exec, -1
    s_nop 2
    s_branch L_s3r2_ok
.p2alignl 12, 0xbf810000
L_helper2:
    v_and_b32 v2, 15, v0
    v_bfe_u32 v3, v0, 4, 2
    v_mov_b32 v16, 0
    v_mov_b32 v17, 0
    v_mov_b32 v18, 0
    v_mov_b32 v19, 0
    v_lshlrev_b32 v8, 4, v0
    v_lshlrev_b32 v9, 2, v1
    v_and_b32 v7, 127, v0
    s_mul_i32 s3, s40, 4672
    s_add_u32 s43, s3, 16896
    v_lshl_add_u32 v6, v7, 2, s43
    ds_write_b128 v8, v[16:19] offset:43520
    ds_write_b128 v8, v[16:19] offset:47616
    ds_write_b128 v8, v[16:19] offset:51712
    ds_write_b128 v8, v[16:19] offset:55808
    ds_write_b32 v9, v16 offset:59904
    ds_write_b32 v6, v16
    s_mul_i32 s3, s40, 8320
    v_lshl_add_u32 v21, v7, 4, s3
    s_mul_i32 s3, s40, 8448
    v_lshl_add_u32 v20, v7, 4, s3
    s_mul_i32 s3, s40, 31008
    s_lshl_b32 s43, s41, 8
    s_add_u32 s3, s3, s43
    s_add_u32 s47, s3, 27648
    s_add_u32 s3, s3, 60416
    v_lshl_add_u32 v8, v3, 4, s3
    v_xor_b32 v6, 3, v2
    v_bfe_u32 v7, v6, 1, 1
    v_add_u32 v7, v6, v7
    v_lshrrev_b32 v7, 1, v7
    s_movk_i32 s3, 544
    v_mad_u32_u24 v22, v2, s3, v8
    v_mad_u32_u24 v23, v6, s3, v8
    v_mad_u32_u24 v24, v7, s3, v8
    s_mul_i32 s3, s33, 4160
    s_add_u32 s3, s3, 43520
    v_xor_b32 v9, 3, v3
    v_and_b32 v6, 1, v9
    v_mul_u32_u24 v6, 2080, v6
    v_lshrrev_b32 v9, 1, v9
    v_lshl_add_u32 v9, v9, 4, v6
    v_add_u32 v9, s3, v9
    v_lshlrev_b32 v6, 5, v2
    v_sub_u32 v6, v9, v6
    v_add_u32 v25, 544, v6
    v_lshrrev_b32 v7, 1, v2
    v_lshrrev_b32 v8, 2, v2
    v_add_u32 v8, 2, v8
    v_min_u32 v7, v7, v8
    v_add3_u32 v7, v7, v2, 39
    v_lshl_add_u32 v26, v7, 5, v9
    v_cmp_gt_u32 vcc, 8, v2
    v_mov_b32 v6, 2128
    v_mov_b32 v7, 1168
    v_cndmask_b32 v6, v6, v7, vcc
    v_add_u32 v27, s3, v6
    s_lshl_b32 s3, s40, 2
    v_mov_b32 v8, s3
    s_waitcnt lgkmcnt(0)
    s_barrier
    s_waitcnt vmcnt(0)
    v_readfirstlane_b32 s46, v11
    s_and_b32 s43, s39, 1
    s_xor_b32 s43, s43, 1
    s_lshl_b32 s43, s43, 4
    s_lshl_b32 s46, s46, s43
    s_and_b32 s46, s46, 0xffff0000
    v_mov_b32 v9, 1069066811
    v_mul_f32 v9, s46, v9
    v_exp_f32 v9, v9
    s_cmp_eq_u32 s41, 0
    s_cselect_b32 s43, 16, 0
    v_cvt_pk_bf16_f32 v9, 0, v9
    v_and_b32 v6, 0x7fff7fff, v14
    v_and_b32 v7, 0x7fff7fff, v15
    v_pk_max_u16 v6, v6, v7
    v_lshrrev_b32 v7, 16, v6
    v_and_b32 v6, 0xffff, v6
    v_max_u32 v6, v6, v7
    v_lshlrev_b32 v12, s43, v12
    v_lshlrev_b32 v13, s43, v13
    v_max_u32_dpp v6, v6, v6 quad_perm:[1,0,3,2] row_mask:0xf bank_mask:0xf
    v_lshlrev_b32 v14, s43, v14
    v_lshlrev_b32 v15, s43, v15
    v_max_u32_dpp v6, v6, v6 quad_perm:[2,3,0,1] row_mask:0xf bank_mask:0xf
    v_and_b32 v12, 0xffff0000, v12
    v_and_b32 v13, 0xffff0000, v13
    v_max_u32_dpp v6, v6, v6 row_half_mirror row_mask:0xf bank_mask:0xf
    v_and_b32 v14, 0xffff0000, v14
    v_and_b32 v15, 0xffff0000, v15
    v_max_u32_dpp v6, v6, v6 row_mirror row_mask:0xf bank_mask:0xf
    v_mov_b32 v32, v6
    v_mul_f32 v12, 1069066811, v12
    v_exp_f32 v12, v12
    v_permlane16_swap_b32 v6, v32
    v_max_u32 v6, v6, v32
    v_mov_b32 v32, v6
    v_mul_f32 v13, v13, v9
    v_cvt_pk_bf16_f32 v12, 0, v12
    v_permlane32_swap_b32 v6, v32
    v_max_u32 v6, v6, v32
    v_mul_f32 v13, 1042479491, v13
    v_mul_f32 v12, v12, v9
    v_fract_f32 v31, v13
    v_mul_f32 v12, 3216550459, v12
    v_exp_f32 v30, v12
    v_cos_f32 v16, v31
    v_sin_f32 v17, v31
    v_lshrrev_b32 v6, 7, v6
    v_mul_f32 v16, v16, v30
    v_mul_f32 v17, v17, v30
    v_max_u32 v6, 8, v6
    v_lshrrev_b32 v7, 23, v9
    v_add_u32 v7, v7, v6
    v_subrev_u32 v7, 127, v7
    v_max_i32 v7, 0, v7
    v_min_i32 v7, 254, v7
    v_lshlrev_b32 v10, 23, v7
    v_sub_u32 v6, 259, v6
    v_and_b32 v9, 0x007fffff, v9
    v_lshl_or_b32 v9, v6, 23, v9
    v_mul_f32 v30, 1098907648, v12
    v_mul_f32 v31, 1098907648, v13
    v_exp_f32 v30, v30
    v_fract_f32 v31, v31
    v_cos_f32 v18, v31
    v_sin_f32 v19, v31
    v_mul_f32 v34, v14, v9
    v_mul_f32 v18, v18, v30
    v_mul_f32 v19, v19, v30
    v_mul_f32 v30, 1132462080, v12
    v_mul_f32 v31, 1132462080, v13
    v_exp_f32 v30, v30
    v_fract_f32 v31, v31
    v_cos_f32 v28, v31
    v_sin_f32 v29, v31
    v_mul_f32 v35, v15, v9
    v_mul_f32 v28, v28, v30
    v_mul_f32 v29, v29, v30
    ds_write_b32 v8, v10 offset:42864
    s_mov_b32 m0, s47
    v_mov_b32 v6, 0x3c00
    v_cvt_pk_f16_f32 v7, v18, -v19
    v_pk_mul_f32 v[30:31], v[18:19], v[18:19] op_sel_hi:[0,1]
    v_pk_fma_f32 v[14:15], v[18:19], v[18:19], v[30:31] op_sel:[1,1,0] op_sel_hi:[1,0,1] neg_lo:[0,1,0]
    v_cvt_pk_f16_f32 v9, v14, -v15
    v_pk_mul_f32 v[30:31], v[14:15], v[18:19] op_sel_hi:[0,1]
    v_pk_fma_f32 v[14:15], v[14:15], v[18:19], v[30:31] op_sel:[1,1,0] op_sel_hi:[1,0,1] neg_lo:[0,1,0]
    v_cvt_pk_f16_f32 v32, v14, -v15
    ds_write_addtid_b32 v6 offset:32768
    ds_write_addtid_b32 v7 offset:33312
    ds_write_addtid_b32 v9 offset:33856
    ds_write_addtid_b32 v32 offset:34400
    v_pk_mul_f32 v[30:31], v[14:15], v[18:19] op_sel_hi:[0,1]
    v_pk_fma_f32 v[14:15], v[14:15], v[18:19], v[30:31] op_sel:[1,1,0] op_sel_hi:[1,0,1] neg_lo:[0,1,0]
    v_cvt_pk_f16_f32 v33, v14, -v15
    v_pk_mul_f32 v[30:31], v[14:15], v[18:19] op_sel_hi:[0,1]
    v_pk_fma_f32 v[14:15], v[14:15], v[18:19], v[30:31] op_sel:[1,1,0] op_sel_hi:[1,0,1] neg_lo:[0,1,0]
    v_cvt_pk_f16_f32 v36, v14, -v15
    v_pk_mul_f32 v[30:31], v[14:15], v[18:19] op_sel_hi:[0,1]
    v_pk_fma_f32 v[14:15], v[14:15], v[18:19], v[30:31] op_sel:[1,1,0] op_sel_hi:[1,0,1] neg_lo:[0,1,0]
    v_cvt_pk_f16_f32 v37, v14, -v15
    v_pk_mul_f32 v[30:31], v[14:15], v[18:19] op_sel_hi:[0,1]
    v_pk_fma_f32 v[14:15], v[14:15], v[18:19], v[30:31] op_sel:[1,1,0] op_sel_hi:[1,0,1] neg_lo:[0,1,0]
    v_cvt_pk_f16_f32 v38, v14, -v15
    ds_write_addtid_b32 v33 offset:34944
    ds_write_addtid_b32 v36 offset:35488
    ds_write_addtid_b32 v37 offset:36032
    ds_write_addtid_b32 v38 offset:36576
    v_pk_mul_f32 v[30:31], v[14:15], v[18:19] op_sel_hi:[0,1]
    v_pk_fma_f32 v[14:15], v[14:15], v[18:19], v[30:31] op_sel:[1,1,0] op_sel_hi:[1,0,1] neg_lo:[0,1,0]
    v_cvt_pk_f16_f32 v39, v14, -v15
    v_pk_mul_f32 v[30:31], v[14:15], v[18:19] op_sel_hi:[0,1]
    v_pk_fma_f32 v[14:15], v[14:15], v[18:19], v[30:31] op_sel:[1,1,0] op_sel_hi:[1,0,1] neg_lo:[0,1,0]
    v_cvt_pk_f16_f32 v7, v14, -v15
    v_pk_mul_f32 v[30:31], v[14:15], v[18:19] op_sel_hi:[0,1]
    v_pk_fma_f32 v[14:15], v[14:15], v[18:19], v[30:31] op_sel:[1,1,0] op_sel_hi:[1,0,1] neg_lo:[0,1,0]
    v_cvt_pk_f16_f32 v9, v14, -v15
    v_pk_mul_f32 v[30:31], v[14:15], v[18:19] op_sel_hi:[0,1]
    v_pk_fma_f32 v[14:15], v[14:15], v[18:19], v[30:31] op_sel:[1,1,0] op_sel_hi:[1,0,1] neg_lo:[0,1,0]
    v_cvt_pk_f16_f32 v32, v14, -v15
    ds_write_addtid_b32 v39 offset:37120
    ds_write_addtid_b32 v7 offset:37664
    ds_write_addtid_b32 v9 offset:38208
    ds_write_addtid_b32 v32 offset:38752
    v_pk_mul_f32 v[30:31], v[14:15], v[18:19] op_sel_hi:[0,1]
    v_pk_fma_f32 v[14:15], v[14:15], v[18:19], v[30:31] op_sel:[1,1,0] op_sel_hi:[1,0,1] neg_lo:[0,1,0]
    v_cvt_pk_f16_f32 v33, v14, -v15
    v_pk_mul_f32 v[30:31], v[14:15], v[18:19] op_sel_hi:[0,1]
    v_pk_fma_f32 v[14:15], v[14:15], v[18:19], v[30:31] op_sel:[1,1,0] op_sel_hi:[1,0,1] neg_lo:[0,1,0]
    v_cvt_pk_f16_f32 v36, v14, -v15
    v_pk_mul_f32 v[30:31], v[14:15], v[18:19] op_sel_hi:[0,1]
    v_pk_fma_f32 v[14:15], v[14:15], v[18:19], v[30:31] op_sel:[1,1,0] op_sel_hi:[1,0,1] neg_lo:[0,1,0]
    v_cvt_pk_f16_f32 v37, v14, -v15
    v_pk_mul_f32 v[30:31], v[14:15], v[18:19] op_sel_hi:[0,1]
    v_pk_fma_f32 v[14:15], v[14:15], v[18:19], v[30:31] op_sel:[1,1,0] op_sel_hi:[1,0,1] neg_lo:[0,1,0]
    v_cvt_pk_f16_f32 v38, v14, -v15
    ds_write_addtid_b32 v33 offset:39296
    ds_write_addtid_b32 v36 offset:39840
    ds_write_addtid_b32 v37 offset:40384
    ds_write_addtid_b32 v38 offset:40928
    ds_read_b128 a[0:3], v22 offset:0
    ds_read_b128 a[4:7], v22 offset:64
    ds_read_b128 a[8:11], v22 offset:128
    ds_read_b128 a[12:15], v22 offset:192
    v_cvt_pk_f16_f32 v39, v34, v35
    v_pk_mul_f32 v[30:31], v[34:35], v[16:17] op_sel_hi:[0,1]
    v_pk_fma_f32 v[12:13], v[34:35], v[16:17], v[30:31] op_sel:[1,1,0] op_sel_hi:[1,0,1] neg_lo:[0,1,0]
    v_cvt_pk_f16_f32 v7, v12, v13
    v_pk_mul_f32 v[30:31], v[12:13], v[16:17] op_sel_hi:[0,1]
    v_pk_fma_f32 v[52:53], v[12:13], v[16:17], v[30:31] op_sel:[1,1,0] op_sel_hi:[1,0,1] neg_lo:[0,1,0]
    v_cvt_pk_f16_f32 v9, v52, v53
    v_pk_mul_f32 v[30:31], v[52:53], v[16:17] op_sel_hi:[0,1]
    v_pk_fma_f32 v[12:13], v[52:53], v[16:17], v[30:31] op_sel:[1,1,0] op_sel_hi:[1,0,1] neg_lo:[0,1,0]
    v_cvt_pk_f16_f32 v32, v12, v13
    ds_write_addtid_b32 v39 offset:41472
    ds_write_addtid_b32 v7 offset:42016
    ds_write_addtid_b32 v9 offset:42560
    ds_write_addtid_b32 v32 offset:43104
    v_pk_mul_f32 v[30:31], v[12:13], v[16:17] op_sel_hi:[0,1]
    v_pk_fma_f32 v[54:55], v[12:13], v[16:17], v[30:31] op_sel:[1,1,0] op_sel_hi:[1,0,1] neg_lo:[0,1,0]
    v_cvt_pk_f16_f32 v33, v54, v55
    v_pk_mul_f32 v[30:31], v[54:55], v[16:17] op_sel_hi:[0,1]
    v_pk_fma_f32 v[12:13], v[54:55], v[16:17], v[30:31] op_sel:[1,1,0] op_sel_hi:[1,0,1] neg_lo:[0,1,0]
    v_cvt_pk_f16_f32 v36, v12, v13
    v_pk_mul_f32 v[30:31], v[12:13], v[16:17] op_sel_hi:[0,1]
    v_pk_fma_f32 v[56:57], v[12:13], v[16:17], v[30:31] op_sel:[1,1,0] op_sel_hi:[1,0,1] neg_lo:[0,1,0]
    v_cvt_pk_f16_f32 v37, v56, v57
    v_pk_mul_f32 v[30:31], v[56:57], v[16:17] op_sel_hi:[0,1]
    v_pk_fma_f32 v[12:13], v[56:57], v[16:17], v[30:31] op_sel:[1,1,0] op_sel_hi:[1,0,1] neg_lo:[0,1,0]
    v_cvt_pk_f16_f32 v38, v12, v13
    ds_write_addtid_b32 v33 offset:43648
    ds_write_addtid_b32 v36 offset:44192
    ds_write_addtid_b32 v37 offset:44736
    ds_write_addtid_b32 v38 offset:45280
    v_pk_mul_f32 v[30:31], v[12:13], v[16:17] op_sel_hi:[0,1]
    v_pk_fma_f32 v[58:59], v[12:13], v[16:17], v[30:31] op_sel:[1,1,0] op_sel_hi:[1,0,1] neg_lo:[0,1,0]
    v_cvt_pk_f16_f32 v39, v58, v59
    v_pk_mul_f32 v[30:31], v[58:59], v[16:17] op_sel_hi:[0,1]
    v_pk_fma_f32 v[12:13], v[58:59], v[16:17], v[30:31] op_sel:[1,1,0] op_sel_hi:[1,0,1] neg_lo:[0,1,0]
    v_cvt_pk_f16_f32 v7, v12, v13
    v_pk_mul_f32 v[30:31], v[12:13], v[16:17] op_sel_hi:[0,1]
    v_pk_fma_f32 v[60:61], v[12:13], v[16:17], v[30:31] op_sel:[1,1,0] op_sel_hi:[1,0,1] neg_lo:[0,1,0]
    v_cvt_pk_f16_f32 v9, v60, v61
    v_pk_mul_f32 v[30:31], v[60:61], v[16:17] op_sel_hi:[0,1]
    v_pk_fma_f32 v[12:13], v[60:61], v[16:17], v[30:31] op_sel:[1,1,0] op_sel_hi:[1,0,1] neg_lo:[0,1,0]
    v_cvt_pk_f16_f32 v32, v12, v13
    ds_write_addtid_b32 v39 offset:45824
    ds_write_addtid_b32 v7 offset:46368
    ds_write_addtid_b32 v9 offset:46912
    ds_write_addtid_b32 v32 offset:47456
    v_pk_mul_f32 v[30:31], v[12:13], v[16:17] op_sel_hi:[0,1]
    v_pk_fma_f32 v[62:63], v[12:13], v[16:17], v[30:31] op_sel:[1,1,0] op_sel_hi:[1,0,1] neg_lo:[0,1,0]
    v_cvt_pk_f16_f32 v33, v62, v63
    v_pk_mul_f32 v[30:31], v[62:63], v[16:17] op_sel_hi:[0,1]
    v_pk_fma_f32 v[12:13], v[62:63], v[16:17], v[30:31] op_sel:[1,1,0] op_sel_hi:[1,0,1] neg_lo:[0,1,0]
    v_cvt_pk_f16_f32 v36, v12, v13
    v_pk_mul_f32 v[30:31], v[12:13], v[16:17] op_sel_hi:[0,1]
    v_pk_fma_f32 v[64:65], v[12:13], v[16:17], v[30:31] op_sel:[1,1,0] op_sel_hi:[1,0,1] neg_lo:[0,1,0]
    v_cvt_pk_f16_f32 v37, v64, v65
    v_pk_mul_f32 v[30:31], v[64:65], v[16:17] op_sel_hi:[0,1]
    v_pk_fma_f32 v[12:13], v[64:65], v[16:17], v[30:31] op_sel:[1,1,0] op_sel_hi:[1,0,1] neg_lo:[0,1,0]
    v_cvt_pk_f16_f32 v38, v12, v13
    ds_write_addtid_b32 v33 offset:48000
    ds_write_addtid_b32 v36 offset:48544
    ds_write_addtid_b32 v37 offset:49088
    ds_write_addtid_b32 v38 offset:49632
    v_pk_mul_f32 v[30:31], v[12:13], v[16:17] op_sel_hi:[0,1]
    v_pk_fma_f32 v[66:67], v[12:13], v[16:17], v[30:31] op_sel:[1,1,0] op_sel_hi:[1,0,1] neg_lo:[0,1,0]
    ds_read_b128 a[16:19], v23 offset:8704
    ds_read_b128 a[20:23], v23 offset:8768
    ds_read_b128 a[24:27], v23 offset:8832
    ds_read_b128 a[28:31], v23 offset:8896
    v_pk_mul_f32 v[30:31], v[34:35], v[28:29] op_sel_hi:[0,1]
    v_pk_fma_f32 v[34:35], v[34:35], v[28:29], v[30:31] op_sel:[1,1,0] op_sel_hi:[1,0,1] neg_lo:[0,1,0]
    v_cvt_pk_f16_f32 v39, v34, v35
    v_pk_mul_f32 v[30:31], v[52:53], v[28:29] op_sel_hi:[0,1]
    v_pk_fma_f32 v[52:53], v[52:53], v[28:29], v[30:31] op_sel:[1,1,0] op_sel_hi:[1,0,1] neg_lo:[0,1,0]
    v_cvt_pk_f16_f32 v7, v52, v53
    v_pk_mul_f32 v[30:31], v[54:55], v[28:29] op_sel_hi:[0,1]
    v_pk_fma_f32 v[54:55], v[54:55], v[28:29], v[30:31] op_sel:[1,1,0] op_sel_hi:[1,0,1] neg_lo:[0,1,0]
    v_cvt_pk_f16_f32 v9, v54, v55
    v_pk_mul_f32 v[30:31], v[56:57], v[28:29] op_sel_hi:[0,1]
    v_pk_fma_f32 v[56:57], v[56:57], v[28:29], v[30:31] op_sel:[1,1,0] op_sel_hi:[1,0,1] neg_lo:[0,1,0]
    v_cvt_pk_f16_f32 v32, v56, v57
    ds_write_addtid_b32 v39 offset:50176
    ds_write_addtid_b32 v7 offset:50720
    ds_write_addtid_b32 v9 offset:51264
    ds_write_addtid_b32 v32 offset:51808
    v_pk_mul_f32 v[30:31], v[58:59], v[28:29] op_sel_hi:[0,1]
    v_pk_fma_f32 v[58:59], v[58:59], v[28:29], v[30:31] op_sel:[1,1,0] op_sel_hi:[1,0,1] neg_lo:[0,1,0]
    v_cvt_pk_f16_f32 v33, v58, v59
    v_pk_mul_f32 v[30:31], v[60:61], v[28:29] op_sel_hi:[0,1]
    v_pk_fma_f32 v[60:61], v[60:61], v[28:29], v[30:31] op_sel:[1,1,0] op_sel_hi:[1,0,1] neg_lo:[0,1,0]
    v_cvt_pk_f16_f32 v36, v60, v61
    v_pk_mul_f32 v[30:31], v[62:63], v[28:29] op_sel_hi:[0,1]
    v_pk_fma_f32 v[62:63], v[62:63], v[28:29], v[30:31] op_sel:[1,1,0] op_sel_hi:[1,0,1] neg_lo:[0,1,0]
    v_cvt_pk_f16_f32 v37, v62, v63
    v_pk_mul_f32 v[30:31], v[64:65], v[28:29] op_sel_hi:[0,1]
    v_pk_fma_f32 v[64:65], v[64:65], v[28:29], v[30:31] op_sel:[1,1,0] op_sel_hi:[1,0,1] neg_lo:[0,1,0]
    v_cvt_pk_f16_f32 v38, v64, v65
    ds_write_addtid_b32 v33 offset:52352
    ds_write_addtid_b32 v36 offset:52896
    ds_write_addtid_b32 v37 offset:53440
    ds_write_addtid_b32 v38 offset:53984
    v_pk_mul_f32 v[30:31], v[66:67], v[28:29] op_sel_hi:[0,1]
    v_pk_fma_f32 v[66:67], v[66:67], v[28:29], v[30:31] op_sel:[1,1,0] op_sel_hi:[1,0,1] neg_lo:[0,1,0]
    v_cvt_pk_f16_f32 v39, v66, v67
    ds_write_addtid_b32 v39 offset:54528
    ds_read_b128 a[32:35], v24 offset:17408
    ds_read_b128 a[36:39], v24 offset:17472
    ds_read_b128 a[40:43], v24 offset:17536
    ds_read_b128 a[44:47], v24 offset:17600
    s_waitcnt lgkmcnt(15)
    v_mfma_f32_16x16x32_f16 v[40:43], a[16:19], a[0:3], 0
    v_mfma_f32_16x16x32_f16 v[40:43], a[20:23], a[4:7], v[40:43]
    s_waitcnt lgkmcnt(14)
    v_mfma_f32_16x16x32_f16 v[40:43], a[24:27], a[8:11], v[40:43]
    s_waitcnt lgkmcnt(13)
    v_mfma_f32_16x16x32_f16 v[40:43], a[28:31], a[12:15], v[40:43]
    v_pk_mul_f32 v[30:31], v[54:55], v[28:29] op_sel_hi:[0,1]
    v_pk_fma_f32 v[54:55], v[54:55], v[28:29], v[30:31] op_sel:[1,1,0] op_sel_hi:[1,0,1] neg_lo:[0,1,0]
    v_cvt_pk_f16_f32 v7, v54, v55
    v_pk_mul_f32 v[30:31], v[58:59], v[28:29] op_sel_hi:[0,1]
    v_pk_fma_f32 v[58:59], v[58:59], v[28:29], v[30:31] op_sel:[1,1,0] op_sel_hi:[1,0,1] neg_lo:[0,1,0]
    v_cvt_pk_f16_f32 v9, v58, v59
    v_pk_mul_f32 v[30:31], v[62:63], v[28:29] op_sel_hi:[0,1]
    v_pk_fma_f32 v[62:63], v[62:63], v[28:29], v[30:31] op_sel:[1,1,0] op_sel_hi:[1,0,1] neg_lo:[0,1,0]
    v_cvt_pk_f16_f32 v32, v62, v63
    v_pk_mul_f32 v[30:31], v[66:67], v[28:29] op_sel_hi:[0,1]
    v_pk_fma_f32 v[66:67], v[66:67], v[28:29], v[30:31] op_sel:[1,1,0] op_sel_hi:[1,0,1] neg_lo:[0,1,0]
    v_cvt_pk_f16_f32 v33, v66, v67
    ds_write_addtid_b32 v7 offset:55616
    ds_write_addtid_b32 v9 offset:56704
    ds_write_addtid_b32 v32 offset:57792
    ds_write_addtid_b32 v33 offset:58880
    v_pk_mul_f32 v[30:31], v[54:55], v[28:29] op_sel_hi:[0,1]
    v_pk_fma_f32 v[54:55], v[54:55], v[28:29], v[30:31] op_sel:[1,1,0] op_sel_hi:[1,0,1] neg_lo:[0,1,0]
    v_cvt_pk_f16_f32 v36, v54, v55
    v_pk_mul_f32 v[30:31], v[58:59], v[28:29] op_sel_hi:[0,1]
    v_pk_fma_f32 v[58:59], v[58:59], v[28:29], v[30:31] op_sel:[1,1,0] op_sel_hi:[1,0,1] neg_lo:[0,1,0]
    v_cvt_pk_f16_f32 v37, v58, v59
    v_pk_mul_f32 v[30:31], v[62:63], v[28:29] op_sel_hi:[0,1]
    v_pk_fma_f32 v[62:63], v[62:63], v[28:29], v[30:31] op_sel:[1,1,0] op_sel_hi:[1,0,1] neg_lo:[0,1,0]
    v_cvt_pk_f16_f32 v38, v62, v63
    v_pk_mul_f32 v[30:31], v[66:67], v[28:29] op_sel_hi:[0,1]
    v_pk_fma_f32 v[66:67], v[66:67], v[28:29], v[30:31] op_sel:[1,1,0] op_sel_hi:[1,0,1] neg_lo:[0,1,0]
    v_cvt_pk_f16_f32 v39, v66, v67
    ds_write_addtid_b32 v36 offset:55072
    ds_write_addtid_b32 v37 offset:56160
    ds_write_addtid_b32 v38 offset:57248
    ds_write_addtid_b32 v39 offset:58336
    ds_write_b128 v25, v[40:43] offset:512
    s_waitcnt lgkmcnt(12)
    v_mfma_f32_16x16x32_f16 v[44:47], a[32:35], a[0:3], 0
    s_waitcnt lgkmcnt(11)
    v_mfma_f32_16x16x32_f16 v[44:47], a[36:39], a[4:7], v[44:47]
    s_waitcnt lgkmcnt(10)
    v_mfma_f32_16x16x32_f16 v[44:47], a[40:43], a[8:11], v[44:47]
    s_waitcnt lgkmcnt(9)
    v_mfma_f32_16x16x32_f16 v[44:47], a[44:47], a[12:15], v[44:47]
    v_pk_mul_f32 v[30:31], v[58:59], v[28:29] op_sel_hi:[0,1]
    v_pk_fma_f32 v[58:59], v[58:59], v[28:29], v[30:31] op_sel:[1,1,0] op_sel_hi:[1,0,1] neg_lo:[0,1,0]
    v_cvt_pk_f16_f32 v7, v58, v59
    v_pk_mul_f32 v[30:31], v[66:67], v[28:29] op_sel_hi:[0,1]
    v_pk_fma_f32 v[66:67], v[66:67], v[28:29], v[30:31] op_sel:[1,1,0] op_sel_hi:[1,0,1] neg_lo:[0,1,0]
    v_cvt_pk_f16_f32 v9, v66, v67
    v_pk_mul_f32 v[30:31], v[58:59], v[28:29] op_sel_hi:[0,1]
    v_pk_fma_f32 v[58:59], v[58:59], v[28:29], v[30:31] op_sel:[1,1,0] op_sel_hi:[1,0,1] neg_lo:[0,1,0]
    v_cvt_pk_f16_f32 v32, v58, v59
    v_pk_mul_f32 v[30:31], v[66:67], v[28:29] op_sel_hi:[0,1]
    v_pk_fma_f32 v[66:67], v[66:67], v[28:29], v[30:31] op_sel:[1,1,0] op_sel_hi:[1,0,1] neg_lo:[0,1,0]
    v_cvt_pk_f16_f32 v33, v66, v67
    ds_write_addtid_b32 v7 offset:61056
    ds_write_addtid_b32 v9 offset:63232
    ds_write_addtid_b32 v32 offset:60512
    ds_write_addtid_b32 v33 offset:62688
    v_pk_mul_f32 v[30:31], v[58:59], v[28:29] op_sel_hi:[0,1]
    v_pk_fma_f32 v[58:59], v[58:59], v[28:29], v[30:31] op_sel:[1,1,0] op_sel_hi:[1,0,1] neg_lo:[0,1,0]
    v_cvt_pk_f16_f32 v36, v58, v59
    v_pk_mul_f32 v[30:31], v[66:67], v[28:29] op_sel_hi:[0,1]
    v_pk_fma_f32 v[66:67], v[66:67], v[28:29], v[30:31] op_sel:[1,1,0] op_sel_hi:[1,0,1] neg_lo:[0,1,0]
    v_cvt_pk_f16_f32 v37, v66, v67
    v_pk_mul_f32 v[30:31], v[58:59], v[28:29] op_sel_hi:[0,1]
    v_pk_fma_f32 v[58:59], v[58:59], v[28:29], v[30:31] op_sel:[1,1,0] op_sel_hi:[1,0,1] neg_lo:[0,1,0]
    v_cvt_pk_f16_f32 v38, v58, v59
    v_pk_mul_f32 v[30:31], v[66:67], v[28:29] op_sel_hi:[0,1]
    v_pk_fma_f32 v[66:67], v[66:67], v[28:29], v[30:31] op_sel:[1,1,0] op_sel_hi:[1,0,1] neg_lo:[0,1,0]
    v_cvt_pk_f16_f32 v39, v66, v67
    ds_write_addtid_b32 v36 offset:59968
    ds_write_addtid_b32 v37 offset:62144
    ds_write_addtid_b32 v38 offset:59424
    ds_write_addtid_b32 v39 offset:61600
    ds_read_b128 a[48:51], v22 offset:22304
    ds_read_b128 a[52:55], v22 offset:22368
    ds_read_b128 a[56:59], v22 offset:22432
    ds_read_b128 a[60:63], v22 offset:22496
    s_barrier
    ds_write_b128 v25, v[44:47]
    v_cmp_gt_u32 vcc, 8, v2
    s_waitcnt lgkmcnt(4)
    v_mfma_f32_16x16x32_f16 v[48:51], a[0:3], a[48:51], 0
    s_waitcnt lgkmcnt(3)
    v_mfma_f32_16x16x32_f16 v[48:51], a[4:7], a[52:55], v[48:51]
    s_waitcnt lgkmcnt(2)
    v_mfma_f32_16x16x32_f16 v[48:51], a[8:11], a[56:59], v[48:51]
    s_waitcnt lgkmcnt(1)
    v_mfma_f32_16x16x32_f16 v[48:51], a[12:15], a[60:63], v[48:51]
    v_cndmask_b32 v31, v44, 0, vcc
    s_nop 6
    v_mov_b32 v68, v51
    v_mov_b32 v69, v50
    v_mov_b32 v70, v49
    v_mov_b32 v71, v48
    v_cndmask_b32 v30, v44, v51, vcc
    ds_write_b128 v26, v[68:71]
    s_mov_b32 exec_lo, 0
    s_mov_b32 exec_hi, 0x80400000
    ds_write_b32 v27, v30 offset:12
    ds_write2_b32 v27, v31, v31 offset0:1 offset1:2
    s_mov_b32 exec_hi, 0x00400000
    ds_write_b32 v27, v30 offset:2080
    s_mov_b64 exec, -1
    s_waitcnt lgkmcnt(0)
    s_barrier
    ds_read_b128 v[22:25], v21 offset:43520
    ds_read_b128 v[34:37], v21 offset:47680
    ds_read_b128 v[26:29], v21 offset:45600
    ds_read_b128 v[38:41], v21 offset:49760
    ds_read_b128 v[30:33], v21 offset:43536
    ds_read_b128 v[42:45], v21 offset:47696
    s_waitcnt lgkmcnt(4)
    v_pk_add_f32 v[22:23], v[22:23], v[34:35]
    v_pk_add_f32 v[24:25], v[24:25], v[36:37]
    s_waitcnt lgkmcnt(2)
    v_pk_add_f32 v[26:27], v[26:27], v[38:39]
    v_pk_add_f32 v[28:29], v[28:29], v[40:41]
    s_waitcnt lgkmcnt(0)
    v_pk_add_f32 v[30:31], v[30:31], v[42:43]
    v_pk_add_f32 v[32:33], v[32:33], v[44:45]
    v_cvt_pk_f16_f32 v12, v22, v23
    v_cvt_pk_f16_f32 v13, v24, v25
    v_cvt_pk_f16_f32 v14, v26, v27
    v_cvt_pk_f16_f32 v15, v28, v29
    v_cvt_pk_f16_f32 v16, v23, v24
    v_cvt_pk_f16_f32 v17, v25, v26
    v_cvt_pk_f16_f32 v18, v27, v28
    v_cvt_pk_f16_f32 v19, v29, v30
    ds_write_b128 v20, v[12:15] offset:0
    ds_write_b128 v20, v[16:19] offset:2112
    v_cvt_pk_f16_f32 v46, v24, v25
    v_cvt_pk_f16_f32 v47, v26, v27
    v_cvt_pk_f16_f32 v48, v28, v29
    v_cvt_pk_f16_f32 v49, v30, v31
    v_cvt_pk_f16_f32 v50, v25, v26
    v_cvt_pk_f16_f32 v51, v27, v28
    v_cvt_pk_f16_f32 v52, v29, v30
    v_cvt_pk_f16_f32 v53, v31, v32
    ds_write_b128 v20, v[46:49] offset:4224
    ds_write_b128 v20, v[50:53] offset:6336
    s_waitcnt lgkmcnt(0)
    s_barrier
    s_lshr_b32 s3, s32, 5
    s_and_b32 s43, s32, 31
    s_cmp_ge_u32 s43, 28
    s_cbranch_scc1 L_h_role1
    s_cmp_ge_u32 s43, 14
    s_cbranch_scc1 L_h_role2
    s_cmp_ge_u32 s43, 7
    s_cselect_b32 s50, 1, 0
    s_cselect_b32 s6, 7, 0
    s_sub_u32 s6, s43, s6
    s_mul_i32 s48, s3, 7
    s_add_u32 s48, s48, s6
    s_lshl_b32 s51, s33, 13
    s_add_u32 s51, s51, 60416
    s_lshl_b32 s3, s33, 7
    v_lshrrev_b32 v6, 2, v1
    v_add_u32 v6, s3, v6
    v_mul_u32_u24 v6, 3584, v6
    v_and_b32 v7, 3, v1
    s_and_b32 s3, s33, 2
    v_xor_b32 v7, s3, v7
    v_lshrrev_b32 v9, 5, v1
    v_xor_b32 v7, v7, v9
    v_lshl_add_u32 v6, v7, 4, v6
    s_lshl_b32 s3, s48, 6
    v_add_u32 v9, s3, v6
    s_cmp_eq_u32 s50, 0
    s_cselect_b32 s4, s22, s24
    s_cselect_b32 s5, s23, s25
    s_barrier
    s_barrier
    s_add_u32 m0, s51, 0
    s_nop 0
    global_load_lds_dwordx4 v9, s[4:5]
    s_add_u32 m0, s51, 1024
    s_add_u32 s4, s4, 57344
    s_addc_u32 s5, s5, 0
    global_load_lds_dwordx4 v9, s[4:5]
    s_add_u32 m0, s51, 2048
    s_add_u32 s4, s4, 57344
    s_addc_u32 s5, s5, 0
    global_load_lds_dwordx4 v9, s[4:5]
    s_add_u32 m0, s51, 3072
    s_add_u32 s4, s4, 57344
    s_addc_u32 s5, s5, 0
    global_load_lds_dwordx4 v9, s[4:5]
    s_barrier
    s_barrier
    s_add_u32 m0, s51, 4096
    s_add_u32 s4, s4, 57344
    s_addc_u32 s5, s5, 0
    global_load_lds_dwordx4 v9, s[4:5]
    s_add_u32 m0, s51, 5120
    s_add_u32 s4, s4, 57344
    s_addc_u32 s5, s5, 0
    global_load_lds_dwordx4 v9, s[4:5]
    s_add_u32 m0, s51, 6144
    s_add_u32 s4, s4, 57344
    s_addc_u32 s5, s5, 0
    global_load_lds_dwordx4 v9, s[4:5]
    s_add_u32 m0, s51, 7168
    s_add_u32 s4, s4, 57344
    s_addc_u32 s5, s5, 0
    global_load_lds_dwordx4 v9, s[4:5]
    s_waitcnt vmcnt(0)
    s_barrier
    s_branch L_h_done
L_h_role1:
    s_lshl_b32 s3, s3, 2
    s_sub_u32 s6, s43, 28
    s_add_u32 s48, s3, s6
    s_mul_i32 s51, s33, 14336
    s_add_u32 s51, s51, 60416
    s_mul_i32 s3, s33, 448
    v_lshrrev_b32 v6, 1, v1
    v_add_u32 v6, s3, v6
    v_lshlrev_b32 v6, 10, v6
    v_and_b32 v7, 1, v1
    v_lshl_add_u32 v6, v7, 4, v6
    s_lshl_b32 s3, s48, 5
    v_add_u32 v9, s3, v6
    s_mov_b64 s[4:5], s[26:27]
    s_barrier
    s_barrier
    s_add_u32 m0, s51, 0
    s_nop 0
    global_load_lds_dwordx4 v9, s[4:5]
    s_add_u32 m0, s51, 1024
    s_add_u32 s4, s4, 32768
    s_addc_u32 s5, s5, 0
    global_load_lds_dwordx4 v9, s[4:5]
    s_add_u32 m0, s51, 2048
    s_add_u32 s4, s4, 32768
    s_addc_u32 s5, s5, 0
    global_load_lds_dwordx4 v9, s[4:5]
    s_add_u32 m0, s51, 3072
    s_add_u32 s4, s4, 32768
    s_addc_u32 s5, s5, 0
    global_load_lds_dwordx4 v9, s[4:5]
    s_barrier
    s_barrier
    s_add_u32 m0, s51, 4096
    s_add_u32 s4, s4, 32768
    s_addc_u32 s5, s5, 0
    global_load_lds_dwordx4 v9, s[4:5]
    s_add_u32 m0, s51, 5120
    s_add_u32 s4, s4, 32768
    s_addc_u32 s5, s5, 0
    global_load_lds_dwordx4 v9, s[4:5]
    s_add_u32 m0, s51, 6144
    s_add_u32 s4, s4, 32768
    s_addc_u32 s5, s5, 0
    global_load_lds_dwordx4 v9, s[4:5]
    s_add_u32 m0, s51, 7168
    s_add_u32 s4, s4, 32768
    s_addc_u32 s5, s5, 0
    global_load_lds_dwordx4 v9, s[4:5]
    s_add_u32 m0, s51, 8192
    s_add_u32 s4, s4, 32768
    s_addc_u32 s5, s5, 0
    global_load_lds_dwordx4 v9, s[4:5]
    s_add_u32 m0, s51, 9216
    s_add_u32 s4, s4, 32768
    s_addc_u32 s5, s5, 0
    global_load_lds_dwordx4 v9, s[4:5]
    s_add_u32 m0, s51, 10240
    s_add_u32 s4, s4, 32768
    s_addc_u32 s5, s5, 0
    global_load_lds_dwordx4 v9, s[4:5]
    s_add_u32 m0, s51, 11264
    s_add_u32 s4, s4, 32768
    s_addc_u32 s5, s5, 0
    global_load_lds_dwordx4 v9, s[4:5]
    s_add_u32 m0, s51, 12288
    s_add_u32 s4, s4, 32768
    s_addc_u32 s5, s5, 0
    global_load_lds_dwordx4 v9, s[4:5]
    s_add_u32 m0, s51, 13312
    s_add_u32 s4, s4, 32768
    s_addc_u32 s5, s5, 0
    global_load_lds_dwordx4 v9, s[4:5]
    s_barrier
    s_waitcnt vmcnt(0)
    s_barrier
    s_branch L_h_done
L_h_role2:
L_h_done:
    s_endpgm
L_end:
    s_endpgm
L_all_end:
.section .rodata,"a"
.p2align 6
.amdhsa_kernel sequential_preLN__ssm_conv_s4d__moe_arch_mod__prompt_kernel
  .amdhsa_next_free_vgpr 256
  .amdhsa_next_free_sgpr 102
  .amdhsa_accum_offset 116
  .amdhsa_group_segment_fixed_size 0
  .amdhsa_kernarg_size 120
  .amdhsa_user_sgpr_count 2
  .amdhsa_user_sgpr_kernarg_segment_ptr 1
  .amdhsa_system_sgpr_workgroup_id_x 1
  .amdhsa_float_denorm_mode_32 3
.end_amdhsa_kernel
```
